```python
import torch

def _softmax(x, axis=-1):
    return torch.softmax(x, dim=axis)
def _gelu(x):
    return torch.nn.functional.gelu(x, approximate="tanh")
def _silu(x):
    return torch.nn.functional.silu(x)
def _sigmoid(x):
    return torch.sigmoid(x)
def _layernorm(x, axis=-1, eps=1e-5):
    m = x.mean(dim=axis, keepdim=True)
    v = x.var(dim=axis, keepdim=True, unbiased=False)
    return (x - m) / torch.sqrt(v + eps)
def _scatter_add(tgt, idx, src, axis=0):
    return tgt.clone().index_add_(axis, idx, src)
def _segment_sum(src, seg, n):
    out = torch.zeros((n,) + src.shape[1:], dtype=src.dtype)
    return out.index_add_(0, seg, src)
def _pad(x, pw):
    flat = tuple(v for pair in reversed(pw) for v in pair)
    return torch.nn.functional.pad(x, flat)

kernel_name = 'recurrent_scan__mha_block__dense_activation_relu__prompt'

def setup_inputs():

    _w = (lambda a: (lambda t: t.to(torch.bfloat16) if t.is_floating_point() else t)(torch.as_tensor(a)))
    def _A_setup():
        B, S, D, H = 1, 2048, 640, 32
        return {
            "x": _w((lambda *s: torch.randn(*s, dtype=torch.bfloat16) * 0.05)(B, S, D)),
            "wqkv": _w((lambda *s: torch.randn(*s, dtype=torch.bfloat16) * 0.05)(D, 3 * D)),
            "wo": _w((lambda *s: torch.randn(*s, dtype=torch.bfloat16) * 0.05)(D, D)),
        }
    _A_in = _A_setup()

    def _B_setup():
        B, S, D, Dff = 1, 2048, 640, 1536
        return {
            "x": _w((lambda *s: torch.randn(*s, dtype=torch.bfloat16) * 0.05)(B, S, D)),
            "w1": _w((lambda *s: torch.randn(*s, dtype=torch.bfloat16) * 0.05)(D, Dff)),
            "w2": _w((lambda *s: torch.randn(*s, dtype=torch.bfloat16) * 0.05)(Dff, D)),
        }
    _B_in = _B_setup()

    return {
        "A_x": _A_in["x"],
        "A_wqkv": _A_in["wqkv"],
        "A_wo": _A_in["wo"],
        "B_x": _B_in["x"],
        "B_w1": _B_in["w1"],
        "B_w2": _B_in["w2"],
    }

def reference(A_x, A_wqkv, A_wo, B_x, B_w1, B_w2):
    def _A_ref(x, wqkv, wo):
        B, S, D = x.shape
        H = 32
        Dh = D // H
        qkv = (lambda x, *d: x.permute(*d))((x @ wqkv).reshape(B, S, 3, H, Dh), 2, 0, 3, 1, 4)
        q, k, v = qkv[0], qkv[1], qkv[2]
        scores = torch.einsum("bhqd,bhkd->bhqk", q, k) * (Dh ** -0.5)
        p = _softmax(scores, axis=-1)
        o = torch.einsum("bhqk,bhkd->bhqd", p, v)
        return (lambda x, *d: x.permute(*d))(o, 0, 2, 1, 3).reshape(B, S, D) @ wo

    def _B_ref(x, w1, w2):
        h = torch.einsum("bsd,df->bsf", x, w1)
        zero = torch.zeros_like(h)
        h = torch.maximum(h, zero)
        return torch.einsum("bsf,fd->bsd", h, w2)

    x = A_x
    xn = _layernorm(x, axis=-1)
    s = _A_ref(xn, A_wqkv, A_wo)
    g = _silu(_B_ref(xn, B_w1, B_w2))
    return x + s * g
```

```asm
; @launch grid=(256,1,1) block=(768,1,1) lds=163840
.amdgcn_target "amdgcn-amd-amdhsa--gfx950"
.text
.p2align 10
.fill 64, 4, 0xbf800000
.globl recurrent_scan__mha_block__dense_activation_relu__prompt_kernel
.p2align 8
.type recurrent_scan__mha_block__dense_activation_relu__prompt_kernel,@function
recurrent_scan__mha_block__dense_activation_relu__prompt_kernel:
    s_cmp_ge_u32 s2, 256
    s_cbranch_scc1 M_END
    s_load_dwordx4 s[4:7], s[0:1], 0
    s_load_dwordx4 s[12:15], s[0:1], 32
    s_load_dwordx2 s[10:11], s[0:1], 64
    s_load_dwordx2 s[8:9], s[0:1], 16
    s_load_dwordx4 s[64:67], s[0:1], 48
    v_lshrrev_b32 v1, 6, v0
    v_and_b32 v0, 63, v0
    v_readfirstlane_b32 s35, v1
    s_and_b32 s3, s2, 7
    s_lshr_b32 s32, s2, 3
    s_mul_i32 s42, s32, 12
    s_add_u32 s42, s42, s35
    s_lshl_b32 s42, s42, 10
    s_cmp_ge_u32 s42, M_END-M_PC
    s_cbranch_scc1 M_S0
    s_getpc_b64 s[40:41]
M_PC:
    s_min_u32 s42, s42, M_END-M_PC-1024
    v_lshl_add_u32 v1, v0, 4, s42
    global_load_dwordx4 v[164:167], v1, s[40:41]
M_S0:
    s_lshr_b32 s62, s3, 2
    s_lshl_b32 s62, s62, 3
    s_and_b32 s40, s32, 7
    s_add_u32 s62, s62, s40
    s_and_b32 s63, s3, 3
    s_lshl_b32 s63, s63, 2
    s_lshr_b32 s41, s32, 3
    s_add_u32 s63, s63, s41
    s_and_b32 s61, s35, 3
    s_lshl_b32 s42, s2, 4
    s_add_u32 s42, s42, s35
    s_cmp_lg_u32 s42, 4
    s_cbranch_scc1 C_NT
    s_memrealtime s[42:43]
    v_mov_b32 v4, 0
    s_waitcnt lgkmcnt(0)
    s_mov_b32 s72, s66
    s_mov_b32 s73, s67
    s_mov_b32 s74, 256
    s_mov_b32 s75, 0x20000
    v_mov_b32 v2, s42
    v_mov_b32 v3, s43
    v_or_b32 v2, 1, v2
    s_mov_b64 exec, 1
    buffer_store_dwordx2 v[2:3], v4, s[72:75], 0 offen offset:8 sc1
    s_mov_b64 exec, -1
C_NT:
    s_cmp_ge_u32 s35, 8
    s_cbranch_scc1 M_COMP
    s_cmp_ge_u32 s35, 4
    s_cbranch_scc1 M_SERV
    s_add_u32 s44, s40, s41
    s_lshr_b32 s41, s63, 2
    s_add_u32 s44, s44, s41
    s_mul_i32 s41, s44, 13
    s_lshr_b32 s41, s41, 6
    s_mul_i32 s41, s41, 5
    s_sub_u32 s44, s44, s41
    s_lshl_b32 s44, s44, 1
    v_lshrrev_b32 v2, 3, v0
    v_and_b32 v3, 7, v0
    v_lshrrev_b32 v4, 4, v0
    v_xor_b32 v3, v3, v4
    v_mul_u32_u24 v2, 1280, v2
    v_lshl_add_u32 v4, v3, 4, v2
    v_xor_b32 v5, 4, v3
    v_lshl_add_u32 v5, v5, 4, v2
    v_lshrrev_b32 v2, 4, v0
    v_bfe_u32 v3, v0, 2, 2
    v_xor_b32 v3, v3, v2
    v_mul_u32_u24 v6, 3840, v2
    v_lshl_add_u32 v6, v3, 6, v6
    v_and_b32 v3, 3, v0
    v_lshl_add_u32 v6, v3, 4, v6
    s_lshl_b32 s45, s62, 2
    s_add_u32 s45, s45, s61
    s_mul_i32 s45, s45, 40960
    s_min_u32 s46, s63, 14
    s_lshl_b32 s46, s46, 8
    s_mul_i32 s41, s61, 61440
    s_add_u32 s46, s46, s41
    s_lshl_b32 s48, s61, 12
    s_waitcnt lgkmcnt(0)
    s_mov_b32 s16, s4
    s_mov_b32 s17, s5
    s_mov_b32 s18, 2621440
    s_mov_b32 s19, 0x20000
    s_mov_b32 s20, s6
    s_mov_b32 s21, s7
    s_mov_b32 s22, 2457600
    s_mov_b32 s23, 0x20000
    s_cmp_eq_u32 s63, 15
    s_cselect_b32 s22, 0, s22
    s_lshl_b32 s40, s44, 7
    s_add_u32 m0, s48, 65536
    s_add_u32 s40, s40, s45
    buffer_load_dwordx4 v4, s[16:19], s40 offen  lds
    s_add_u32 m0, m0, 1024
    s_add_u32 s40, s40, 10240
    buffer_load_dwordx4 v5, s[16:19], s40 offen  lds
    s_add_u32 m0, m0, 1024
    s_add_u32 s40, s40, 10240
    buffer_load_dwordx4 v4, s[16:19], s40 offen  lds
    s_add_u32 m0, m0, 1024
    s_add_u32 s40, s40, 10240
    buffer_load_dwordx4 v5, s[16:19], s40 offen  lds
    s_mul_i32 s41, s44, 245760
    s_add_u32 m0, s48, 98304
    s_add_u32 s41, s41, s46
    buffer_load_dwordx4 v6, s[20:23], s41 offen  lds
    s_add_u32 m0, m0, 1024
    s_add_u32 s41, s41, 15360
    buffer_load_dwordx4 v6, s[20:23], s41 offen  lds
    s_add_u32 m0, m0, 1024
    s_add_u32 s41, s41, 15360
    buffer_load_dwordx4 v6, s[20:23], s41 offen  lds
    s_add_u32 m0, m0, 1024
    s_add_u32 s41, s41, 15360
    buffer_load_dwordx4 v6, s[20:23], s41 offen  lds
    s_add_u32 s44, s44, 1
    s_cmp_eq_u32 s44, 10
    s_cselect_b32 s44, 0, s44
    s_mov_b32 s28, s12
    s_mov_b32 s29, s13
    s_mov_b32 s30, 1966080
    s_mov_b32 s31, 0x20000
    s_mov_b32 s24, s10
    s_mov_b32 s25, s11
    s_mov_b32 s26, 19955712
    s_mov_b32 s27, 0x20000
    s_mul_i32 s47, s63, 192
    s_mul_i32 s41, s61, 49152
    s_add_u32 s47, s47, s41
    s_mul_i32 s49, s61, 3072
    s_movk_i32 s41, 5462
    v_add_u32 v2, 0, v0
    v_mul_u32_u24 v3, s41, v2
    v_lshrrev_b32 v3, 16, v3
    v_mul_u32_u24 v7, 2880, v3
    v_lshl_add_u32 v7, v2, 4, v7
    v_add_u32 v2, 64, v0
    v_mul_u32_u24 v3, s41, v2
    v_lshrrev_b32 v3, 16, v3
    v_mul_u32_u24 v8, 2880, v3
    v_lshl_add_u32 v8, v2, 4, v8
    v_add_u32 v2, 128, v0
    v_mul_u32_u24 v3, s41, v2
    v_lshrrev_b32 v3, 16, v3
    v_mul_u32_u24 v9, 2880, v3
    v_lshl_add_u32 v9, v2, 4, v9
    s_lshr_b32 s33, s3, 1
    s_lshl_b32 s33, s33, 4
    s_and_b32 s40, s32, 15
    s_add_u32 s33, s33, s40
    s_and_b32 s34, s3, 1
    s_lshl_b32 s34, s34, 1
    s_lshr_b32 s40, s32, 4
    s_add_u32 s34, s34, s40
    s_lshl_b32 s36, s3, 2
    s_and_b32 s40, s32, 3
    s_add_u32 s36, s36, s40
    s_lshr_b32 s37, s32, 2
    s_mul_i32 s38, s36, 163840
    s_add_u32 s38, s38, 2621440
    s_mul_i32 s60, s37, 20480
    s_lshl_b32 s40, s44, 7
    s_add_u32 m0, s48, 81920
    s_add_u32 s40, s40, s45
    buffer_load_dwordx4 v4, s[16:19], s40 offen  lds
    s_add_u32 m0, m0, 1024
    s_add_u32 s40, s40, 10240
    buffer_load_dwordx4 v5, s[16:19], s40 offen  lds
    s_add_u32 m0, m0, 1024
    s_add_u32 s40, s40, 10240
    buffer_load_dwordx4 v4, s[16:19], s40 offen  lds
    s_add_u32 m0, m0, 1024
    s_add_u32 s40, s40, 10240
    buffer_load_dwordx4 v5, s[16:19], s40 offen  lds
    s_mul_i32 s41, s44, 245760
    s_add_u32 m0, s48, 114688
    s_add_u32 s41, s41, s46
    buffer_load_dwordx4 v6, s[20:23], s41 offen  lds
    s_add_u32 m0, m0, 1024
    s_add_u32 s41, s41, 15360
    buffer_load_dwordx4 v6, s[20:23], s41 offen  lds
    s_add_u32 m0, m0, 1024
    s_add_u32 s41, s41, 15360
    buffer_load_dwordx4 v6, s[20:23], s41 offen  lds
    s_add_u32 m0, m0, 1024
    s_add_u32 s41, s41, 15360
    buffer_load_dwordx4 v6, s[20:23], s41 offen  lds
    s_add_u32 s44, s44, 1
    s_cmp_eq_u32 s44, 10
    s_cselect_b32 s44, 0, s44
    s_waitcnt vmcnt(8)
    s_barrier
    s_lshl_b32 s40, s44, 7
    s_add_u32 m0, s48, 0
    s_add_u32 s40, s40, s45
    buffer_load_dwordx4 v4, s[16:19], s40 offen  lds
    s_add_u32 m0, m0, 1024
    s_add_u32 s40, s40, 10240
    buffer_load_dwordx4 v5, s[16:19], s40 offen  lds
    s_add_u32 m0, m0, 1024
    s_add_u32 s40, s40, 10240
    buffer_load_dwordx4 v4, s[16:19], s40 offen  lds
    s_add_u32 m0, m0, 1024
    s_add_u32 s40, s40, 10240
    buffer_load_dwordx4 v5, s[16:19], s40 offen  lds
    s_mul_i32 s41, s44, 245760
    s_add_u32 m0, s48, 131072
    s_add_u32 s41, s41, s46
    buffer_load_dwordx4 v6, s[20:23], s41 offen  lds
    s_add_u32 m0, m0, 1024
    s_add_u32 s41, s41, 15360
    buffer_load_dwordx4 v6, s[20:23], s41 offen  lds
    s_add_u32 m0, m0, 1024
    s_add_u32 s41, s41, 15360
    buffer_load_dwordx4 v6, s[20:23], s41 offen  lds
    s_add_u32 m0, m0, 1024
    s_add_u32 s41, s41, 15360
    buffer_load_dwordx4 v6, s[20:23], s41 offen  lds
    s_add_u32 s44, s44, 1
    s_cmp_eq_u32 s44, 10
    s_cselect_b32 s44, 0, s44
    s_waitcnt vmcnt(8)
    s_barrier
    s_lshl_b32 s40, s44, 7
    s_add_u32 m0, s48, 16384
    s_add_u32 s40, s40, s45
    buffer_load_dwordx4 v4, s[16:19], s40 offen  lds
    s_add_u32 m0, m0, 1024
    s_add_u32 s40, s40, 10240
    buffer_load_dwordx4 v5, s[16:19], s40 offen  lds
    s_add_u32 m0, m0, 1024
    s_add_u32 s40, s40, 10240
    buffer_load_dwordx4 v4, s[16:19], s40 offen  lds
    s_add_u32 m0, m0, 1024
    s_add_u32 s40, s40, 10240
    buffer_load_dwordx4 v5, s[16:19], s40 offen  lds
    s_mul_i32 s41, s44, 245760
    s_add_u32 m0, s48, 147456
    s_add_u32 s41, s41, s46
    buffer_load_dwordx4 v6, s[20:23], s41 offen  lds
    s_add_u32 m0, m0, 1024
    s_add_u32 s41, s41, 15360
    buffer_load_dwordx4 v6, s[20:23], s41 offen  lds
    s_add_u32 m0, m0, 1024
    s_add_u32 s41, s41, 15360
    buffer_load_dwordx4 v6, s[20:23], s41 offen  lds
    s_add_u32 m0, m0, 1024
    s_add_u32 s41, s41, 15360
    buffer_load_dwordx4 v6, s[20:23], s41 offen  lds
    s_add_u32 s44, s44, 1
    s_cmp_eq_u32 s44, 10
    s_cselect_b32 s44, 0, s44
    s_lshl_b32 s40, s44, 7
    s_add_u32 m0, s48, 32768
    s_add_u32 s40, s40, s45
    buffer_load_dwordx4 v4, s[16:19], s40 offen  lds
    s_add_u32 m0, m0, 1024
    s_add_u32 s40, s40, 10240
    buffer_load_dwordx4 v5, s[16:19], s40 offen  lds
    s_add_u32 m0, m0, 1024
    s_add_u32 s40, s40, 10240
    buffer_load_dwordx4 v4, s[16:19], s40 offen  lds
    s_add_u32 m0, m0, 1024
    s_add_u32 s40, s40, 10240
    buffer_load_dwordx4 v5, s[16:19], s40 offen  lds
    s_waitcnt vmcnt(12)
    s_barrier
    s_mul_i32 s41, s44, 245760
    s_add_u32 m0, s48, 98304
    s_add_u32 s41, s41, s46
    buffer_load_dwordx4 v6, s[20:23], s41 offen  lds
    s_add_u32 m0, m0, 1024
    s_add_u32 s41, s41, 15360
    buffer_load_dwordx4 v6, s[20:23], s41 offen  lds
    s_add_u32 m0, m0, 1024
    s_add_u32 s41, s41, 15360
    buffer_load_dwordx4 v6, s[20:23], s41 offen  lds
    s_add_u32 m0, m0, 1024
    s_add_u32 s41, s41, 15360
    buffer_load_dwordx4 v6, s[20:23], s41 offen  lds
    s_add_u32 s44, s44, 1
    s_cmp_eq_u32 s44, 10
    s_cselect_b32 s44, 0, s44
    s_lshl_b32 s40, s44, 7
    s_add_u32 m0, s48, 49152
    s_add_u32 s40, s40, s45
    buffer_load_dwordx4 v4, s[16:19], s40 offen  lds
    s_add_u32 m0, m0, 1024
    s_add_u32 s40, s40, 10240
    buffer_load_dwordx4 v5, s[16:19], s40 offen  lds
    s_add_u32 m0, m0, 1024
    s_add_u32 s40, s40, 10240
    buffer_load_dwordx4 v4, s[16:19], s40 offen  lds
    s_add_u32 m0, m0, 1024
    s_add_u32 s40, s40, 10240
    buffer_load_dwordx4 v5, s[16:19], s40 offen  lds
    s_mul_i32 s41, s44, 245760
    s_add_u32 m0, s48, 114688
    s_add_u32 s41, s41, s46
    buffer_load_dwordx4 v6, s[20:23], s41 offen  lds
    s_add_u32 m0, m0, 1024
    s_add_u32 s41, s41, 15360
    buffer_load_dwordx4 v6, s[20:23], s41 offen  lds
    s_add_u32 m0, m0, 1024
    s_add_u32 s41, s41, 15360
    buffer_load_dwordx4 v6, s[20:23], s41 offen  lds
    s_add_u32 m0, m0, 1024
    s_add_u32 s41, s41, 15360
    buffer_load_dwordx4 v6, s[20:23], s41 offen  lds
    s_add_u32 s44, s44, 1
    s_cmp_eq_u32 s44, 10
    s_cselect_b32 s44, 0, s44
    s_waitcnt vmcnt(16)
    s_barrier
    s_lshl_b32 s40, s44, 7
    s_add_u32 m0, s48, 65536
    s_add_u32 s40, s40, s45
    buffer_load_dwordx4 v4, s[16:19], s40 offen  lds
    s_add_u32 m0, m0, 1024
    s_add_u32 s40, s40, 10240
    buffer_load_dwordx4 v5, s[16:19], s40 offen  lds
    s_add_u32 m0, m0, 1024
    s_add_u32 s40, s40, 10240
    buffer_load_dwordx4 v4, s[16:19], s40 offen  lds
    s_add_u32 m0, m0, 1024
    s_add_u32 s40, s40, 10240
    buffer_load_dwordx4 v5, s[16:19], s40 offen  lds
    s_mul_i32 s41, s44, 245760
    s_add_u32 m0, s48, 131072
    s_add_u32 s41, s41, s46
    buffer_load_dwordx4 v6, s[20:23], s41 offen  lds
    s_add_u32 m0, m0, 1024
    s_add_u32 s41, s41, 15360
    buffer_load_dwordx4 v6, s[20:23], s41 offen  lds
    s_add_u32 m0, m0, 1024
    s_add_u32 s41, s41, 15360
    buffer_load_dwordx4 v6, s[20:23], s41 offen  lds
    s_add_u32 m0, m0, 1024
    s_add_u32 s41, s41, 15360
    buffer_load_dwordx4 v6, s[20:23], s41 offen  lds
    s_add_u32 s44, s44, 1
    s_cmp_eq_u32 s44, 10
    s_cselect_b32 s44, 0, s44
    s_waitcnt vmcnt(16)
    s_barrier
    s_lshl_b32 s40, s44, 7
    s_add_u32 m0, s48, 81920
    s_add_u32 s40, s40, s45
    buffer_load_dwordx4 v4, s[16:19], s40 offen  lds
    s_add_u32 m0, m0, 1024
    s_add_u32 s40, s40, 10240
    buffer_load_dwordx4 v5, s[16:19], s40 offen  lds
    s_add_u32 m0, m0, 1024
    s_add_u32 s40, s40, 10240
    buffer_load_dwordx4 v4, s[16:19], s40 offen  lds
    s_add_u32 m0, m0, 1024
    s_add_u32 s40, s40, 10240
    buffer_load_dwordx4 v5, s[16:19], s40 offen  lds
    s_mul_i32 s41, s44, 245760
    s_add_u32 m0, s48, 147456
    s_add_u32 s41, s41, s46
    buffer_load_dwordx4 v6, s[20:23], s41 offen  lds
    s_add_u32 m0, m0, 1024
    s_add_u32 s41, s41, 15360
    buffer_load_dwordx4 v6, s[20:23], s41 offen  lds
    s_add_u32 m0, m0, 1024
    s_add_u32 s41, s41, 15360
    buffer_load_dwordx4 v6, s[20:23], s41 offen  lds
    s_add_u32 m0, m0, 1024
    s_add_u32 s41, s41, 15360
    buffer_load_dwordx4 v6, s[20:23], s41 offen  lds
    s_add_u32 s44, s44, 1
    s_cmp_eq_u32 s44, 10
    s_cselect_b32 s44, 0, s44
    s_waitcnt vmcnt(16)
    s_barrier
    s_lshl_b32 s40, s44, 7
    s_add_u32 m0, s48, 0
    s_add_u32 s40, s40, s45
    buffer_load_dwordx4 v4, s[16:19], s40 offen  lds
    s_add_u32 m0, m0, 1024
    s_add_u32 s40, s40, 10240
    buffer_load_dwordx4 v5, s[16:19], s40 offen  lds
    s_add_u32 m0, m0, 1024
    s_add_u32 s40, s40, 10240
    buffer_load_dwordx4 v4, s[16:19], s40 offen  lds
    s_add_u32 m0, m0, 1024
    s_add_u32 s40, s40, 10240
    buffer_load_dwordx4 v5, s[16:19], s40 offen  lds
    s_mul_i32 s41, s44, 245760
    s_add_u32 m0, s48, 98304
    s_add_u32 s41, s41, s46
    buffer_load_dwordx4 v6, s[20:23], s41 offen  lds
    s_add_u32 m0, m0, 1024
    s_add_u32 s41, s41, 15360
    buffer_load_dwordx4 v6, s[20:23], s41 offen  lds
    s_add_u32 m0, m0, 1024
    s_add_u32 s41, s41, 15360
    buffer_load_dwordx4 v6, s[20:23], s41 offen  lds
    s_add_u32 m0, m0, 1024
    s_add_u32 s41, s41, 15360
    buffer_load_dwordx4 v6, s[20:23], s41 offen  lds
    s_add_u32 s44, s44, 1
    s_cmp_eq_u32 s44, 10
    s_cselect_b32 s44, 0, s44
    s_waitcnt vmcnt(16)
    s_barrier
    s_lshl_b32 s40, s44, 7
    s_add_u32 m0, s48, 16384
    s_add_u32 s40, s40, s45
    buffer_load_dwordx4 v4, s[16:19], s40 offen  lds
    s_add_u32 m0, m0, 1024
    s_add_u32 s40, s40, 10240
    buffer_load_dwordx4 v5, s[16:19], s40 offen  lds
    s_add_u32 m0, m0, 1024
    s_add_u32 s40, s40, 10240
    buffer_load_dwordx4 v4, s[16:19], s40 offen  lds
    s_add_u32 m0, m0, 1024
    s_add_u32 s40, s40, 10240
    buffer_load_dwordx4 v5, s[16:19], s40 offen  lds
    s_mul_i32 s41, s44, 245760
    s_add_u32 m0, s48, 114688
    s_add_u32 s41, s41, s46
    buffer_load_dwordx4 v6, s[20:23], s41 offen  lds
    s_add_u32 m0, m0, 1024
    s_add_u32 s41, s41, 15360
    buffer_load_dwordx4 v6, s[20:23], s41 offen  lds
    s_add_u32 m0, m0, 1024
    s_add_u32 s41, s41, 15360
    buffer_load_dwordx4 v6, s[20:23], s41 offen  lds
    s_add_u32 m0, m0, 1024
    s_add_u32 s41, s41, 15360
    buffer_load_dwordx4 v6, s[20:23], s41 offen  lds
    s_add_u32 s44, s44, 1
    s_cmp_eq_u32 s44, 10
    s_cselect_b32 s44, 0, s44
    s_waitcnt vmcnt(16)
    s_barrier
    s_waitcnt vmcnt(8)
    s_barrier
    s_add_u32 s44, s44, 4
    s_sub_u32 s41, s44, 10
    s_cmp_ge_u32 s44, 10
    s_cselect_b32 s44, s41, s44
    s_mul_i32 s41, s44, 196608
    s_add_u32 m0, s49, 131072
    s_add_u32 s41, s41, s47
    buffer_load_dwordx4 v7, s[28:31], s41 offen lds
    s_add_u32 m0, m0, 1024
    s_nop 0
    buffer_load_dwordx4 v8, s[28:31], s41 offen lds
    s_add_u32 m0, m0, 1024
    s_nop 0
    buffer_load_dwordx4 v9, s[28:31], s41 offen lds
    s_add_u32 s44, s44, 1
    s_cmp_eq_u32 s44, 10
    s_cselect_b32 s44, 0, s44
    s_mul_i32 s41, s44, 196608
    s_add_u32 m0, s49, 147456
    s_add_u32 s41, s41, s47
    buffer_load_dwordx4 v7, s[28:31], s41 offen lds
    s_add_u32 m0, m0, 1024
    s_nop 0
    buffer_load_dwordx4 v8, s[28:31], s41 offen lds
    s_add_u32 m0, m0, 1024
    s_nop 0
    buffer_load_dwordx4 v9, s[28:31], s41 offen lds
    s_add_u32 s44, s44, 1
    s_cmp_eq_u32 s44, 10
    s_cselect_b32 s44, 0, s44
    s_waitcnt vmcnt(6)
    s_barrier
    s_barrier
    s_waitcnt vmcnt(0)
    s_barrier
    s_mul_i32 s41, s44, 196608
    s_add_u32 m0, s49, 98304
    s_add_u32 s41, s41, s47
    buffer_load_dwordx4 v7, s[28:31], s41 offen lds
    s_add_u32 m0, m0, 1024
    s_nop 0
    buffer_load_dwordx4 v8, s[28:31], s41 offen lds
    s_add_u32 m0, m0, 1024
    s_nop 0
    buffer_load_dwordx4 v9, s[28:31], s41 offen lds
    s_add_u32 s44, s44, 1
    s_cmp_eq_u32 s44, 10
    s_cselect_b32 s44, 0, s44
    s_mul_i32 s41, s44, 196608
    s_add_u32 m0, s49, 114688
    s_add_u32 s41, s41, s47
    buffer_load_dwordx4 v7, s[28:31], s41 offen lds
    s_add_u32 m0, m0, 1024
    s_nop 0
    buffer_load_dwordx4 v8, s[28:31], s41 offen lds
    s_add_u32 m0, m0, 1024
    s_nop 0
    buffer_load_dwordx4 v9, s[28:31], s41 offen lds
    s_add_u32 s44, s44, 1
    s_cmp_eq_u32 s44, 10
    s_cselect_b32 s44, 0, s44
    s_waitcnt vmcnt(6)
    s_barrier
    s_mul_i32 s41, s44, 196608
    s_add_u32 m0, s49, 131072
    s_add_u32 s41, s41, s47
    buffer_load_dwordx4 v7, s[28:31], s41 offen lds
    s_add_u32 m0, m0, 1024
    s_nop 0
    buffer_load_dwordx4 v8, s[28:31], s41 offen lds
    s_add_u32 m0, m0, 1024
    s_nop 0
    buffer_load_dwordx4 v9, s[28:31], s41 offen lds
    s_add_u32 s44, s44, 1
    s_cmp_eq_u32 s44, 10
    s_cselect_b32 s44, 0, s44
    s_waitcnt vmcnt(6)
    s_barrier
    s_mul_i32 s41, s44, 196608
    s_add_u32 m0, s49, 147456
    s_add_u32 s41, s41, s47
    buffer_load_dwordx4 v7, s[28:31], s41 offen lds
    s_add_u32 m0, m0, 1024
    s_nop 0
    buffer_load_dwordx4 v8, s[28:31], s41 offen lds
    s_add_u32 m0, m0, 1024
    s_nop 0
    buffer_load_dwordx4 v9, s[28:31], s41 offen lds
    s_add_u32 s44, s44, 1
    s_cmp_eq_u32 s44, 10
    s_cselect_b32 s44, 0, s44
    s_waitcnt vmcnt(6)
    s_barrier
    s_lshl_b32 s40, s44, 7
    s_add_u32 m0, s48, 32768
    s_add_u32 s40, s40, s45
    buffer_load_dwordx4 v4, s[16:19], s40 offen  lds
    s_add_u32 m0, m0, 1024
    s_add_u32 s40, s40, 10240
    buffer_load_dwordx4 v5, s[16:19], s40 offen  lds
    s_add_u32 m0, m0, 1024
    s_add_u32 s40, s40, 10240
    buffer_load_dwordx4 v4, s[16:19], s40 offen  lds
    s_add_u32 m0, m0, 1024
    s_add_u32 s40, s40, 10240
    buffer_load_dwordx4 v5, s[16:19], s40 offen  lds
    s_mul_i32 s41, s44, 196608
    s_add_u32 m0, s49, 98304
    s_add_u32 s41, s41, s47
    buffer_load_dwordx4 v7, s[28:31], s41 offen lds
    s_add_u32 m0, m0, 1024
    s_nop 0
    buffer_load_dwordx4 v8, s[28:31], s41 offen lds
    s_add_u32 m0, m0, 1024
    s_nop 0
    buffer_load_dwordx4 v9, s[28:31], s41 offen lds
    s_add_u32 s44, s44, 1
    s_cmp_eq_u32 s44, 10
    s_cselect_b32 s44, 0, s44
    s_waitcnt vmcnt(10)
    s_barrier
    s_lshl_b32 s40, s44, 7
    s_add_u32 m0, s48, 49152
    s_add_u32 s40, s40, s45
    buffer_load_dwordx4 v4, s[16:19], s40 offen  lds
    s_add_u32 m0, m0, 1024
    s_add_u32 s40, s40, 10240
    buffer_load_dwordx4 v5, s[16:19], s40 offen  lds
    s_add_u32 m0, m0, 1024
    s_add_u32 s40, s40, 10240
    buffer_load_dwordx4 v4, s[16:19], s40 offen  lds
    s_add_u32 m0, m0, 1024
    s_add_u32 s40, s40, 10240
    buffer_load_dwordx4 v5, s[16:19], s40 offen  lds
    s_mul_i32 s41, s44, 196608
    s_add_u32 m0, s49, 114688
    s_add_u32 s41, s41, s47
    buffer_load_dwordx4 v7, s[28:31], s41 offen lds
    s_add_u32 m0, m0, 1024
    s_nop 0
    buffer_load_dwordx4 v8, s[28:31], s41 offen lds
    s_add_u32 m0, m0, 1024
    s_nop 0
    buffer_load_dwordx4 v9, s[28:31], s41 offen lds
    s_add_u32 s44, s44, 1
    s_cmp_eq_u32 s44, 10
    s_cselect_b32 s44, 0, s44
    s_waitcnt vmcnt(14)
    s_barrier
    s_lshl_b32 s40, s44, 7
    s_add_u32 m0, s48, 65536
    s_add_u32 s40, s40, s45
    buffer_load_dwordx4 v4, s[16:19], s40 offen  lds
    s_add_u32 m0, m0, 1024
    s_add_u32 s40, s40, 10240
    buffer_load_dwordx4 v5, s[16:19], s40 offen  lds
    s_add_u32 m0, m0, 1024
    s_add_u32 s40, s40, 10240
    buffer_load_dwordx4 v4, s[16:19], s40 offen  lds
    s_add_u32 m0, m0, 1024
    s_add_u32 s40, s40, 10240
    buffer_load_dwordx4 v5, s[16:19], s40 offen  lds
    s_mul_i32 s41, s44, 196608
    s_add_u32 m0, s49, 131072
    s_add_u32 s41, s41, s47
    buffer_load_dwordx4 v7, s[28:31], s41 offen lds
    s_add_u32 m0, m0, 1024
    s_nop 0
    buffer_load_dwordx4 v8, s[28:31], s41 offen lds
    s_add_u32 m0, m0, 1024
    s_nop 0
    buffer_load_dwordx4 v9, s[28:31], s41 offen lds
    s_add_u32 s44, s44, 1
    s_cmp_eq_u32 s44, 10
    s_cselect_b32 s44, 0, s44
    s_waitcnt vmcnt(14)
    s_barrier
    s_lshl_b32 s40, s44, 7
    s_add_u32 m0, s48, 81920
    s_add_u32 s40, s40, s45
    buffer_load_dwordx4 v4, s[16:19], s40 offen  lds
    s_add_u32 m0, m0, 1024
    s_add_u32 s40, s40, 10240
    buffer_load_dwordx4 v5, s[16:19], s40 offen  lds
    s_add_u32 m0, m0, 1024
    s_add_u32 s40, s40, 10240
    buffer_load_dwordx4 v4, s[16:19], s40 offen  lds
    s_add_u32 m0, m0, 1024
    s_add_u32 s40, s40, 10240
    buffer_load_dwordx4 v5, s[16:19], s40 offen  lds
    s_mul_i32 s41, s44, 196608
    s_add_u32 m0, s49, 147456
    s_add_u32 s41, s41, s47
    buffer_load_dwordx4 v7, s[28:31], s41 offen lds
    s_add_u32 m0, m0, 1024
    s_nop 0
    buffer_load_dwordx4 v8, s[28:31], s41 offen lds
    s_add_u32 m0, m0, 1024
    s_nop 0
    buffer_load_dwordx4 v9, s[28:31], s41 offen lds
    s_add_u32 s44, s44, 1
    s_cmp_eq_u32 s44, 10
    s_cselect_b32 s44, 0, s44
    s_waitcnt vmcnt(14)
    s_barrier
    s_waitcnt vmcnt(7)
    s_barrier
    v_lshlrev_b32 v1, 4, v0
    s_lshl_b32 s39, s37, 3
    s_add_u32 s39, s39, s35
    s_mul_i32 s40, s36, 81920
    s_mul_i32 s41, s39, 1280
    s_add_u32 s40, s40, s41
    v_and_b32 v4, 31, v0
    v_lshlrev_b32 v5, 3, v4
    s_lshl_b32 s41, s35, 10
    buffer_load_dwordx4 v[124:127], v1, s[24:27], s40 offen sc1
    buffer_load_dwordx2 v[122:123], v5, s[24:27], s40 offen offset:1024 sc1
    s_add_u32 s40, s38, s60
    v_lshlrev_b32 v7, 3, v0
    buffer_load_dwordx4 v[112:115], v1, s[24:27], s40 offen sc1
    buffer_load_dwordx4 v[116:119], v1, s[24:27], s40 offen offset:1024 sc1
    buffer_load_dwordx2 v[120:121], v7, s[24:27], s40 offen offset:2048 sc1
    s_mov_b32 m0, s41
    s_add_u32 s42, s41, s60
    s_sub_u32 s43, s42, 163840
    s_cmp_ge_u32 s42, 163840
    s_cselect_b32 s42, s43, s42
    s_add_u32 s42, s42, s38
    buffer_load_dwordx4 v1, s[24:27], s42 offen sc1 lds
    s_add_u32 s41, s41, 8192
    s_mov_b32 m0, s41
    s_add_u32 s42, s41, s60
    s_sub_u32 s43, s42, 163840
    s_cmp_ge_u32 s42, 163840
    s_cselect_b32 s42, s43, s42
    s_add_u32 s42, s42, s38
    buffer_load_dwordx4 v1, s[24:27], s42 offen sc1 lds
    s_add_u32 s41, s41, 8192
    s_waitcnt vmcnt(7)
    s_barrier
    s_branch M_ATT
M_SERV:
    v_lshlrev_b32 v10, 4, v0
    v_lshlrev_b32 v11, 7, v0
    s_add_u32 s44, s40, s41
    s_lshr_b32 s41, s63, 2
    s_add_u32 s44, s44, s41
    s_mul_i32 s41, s44, 13
    s_lshr_b32 s41, s41, 6
    s_mul_i32 s41, s41, 5
    s_sub_u32 s44, s44, s41
    s_lshl_b32 s44, s44, 1
    v_mov_b32 v12, 0
    v_mov_b32 v13, 1
    s_lshl_b32 s58, s2, 2
    s_add_u32 s58, s58, s61
    s_waitcnt lgkmcnt(0)
    s_mov_b32 s24, s10
    s_mov_b32 s25, s11
    s_mov_b32 s26, 19955712
    s_mov_b32 s27, 0x20000
    s_mov_b32 s72, s66
    s_mov_b32 s73, s67
    s_mov_b32 s74, 256
    s_mov_b32 s75, 0x20000
    v_and_b32 v1, 31, v0
    v_lshrrev_b32 v2, 5, v0
    v_bfe_u32 v3, v0, 1, 3
    v_xor_b32 v3, v3, v2
    v_lshlrev_b32 v3, 4, v3
    v_lshl_add_u32 v3, v1, 7, v3
    s_lshl_b32 s40, s61, 12
    s_add_u32 s40, s40, 65536
    v_add_u32 v140, s40, v3
    v_xor_b32 v141, 32, v140
    v_xor_b32 v142, 64, v140
    v_xor_b32 v143, 96, v140
    v_bfe_u32 v3, v0, 2, 2
    v_lshl_add_u32 v4, v2, 3, v3
    v_and_b32 v5, 16, v0
    v_lshlrev_b32 v5, 1, v5
    v_and_b32 v6, 3, v0
    v_lshl_add_u32 v5, v6, 3, v5
    v_add_u32 v5, 98304, v5
    v_lshl_add_u32 v144, v4, 8, v5
    v_lshl_add_u32 v144, v3, 6, v144
    v_xor_b32 v145, 64, v144
    v_xor_b32 v146, 128, v144
    v_xor_b32 v147, 192, v144
    v_mul_u32_u24 v148, 192, v4
    v_add3_u32 v148, v148, v5, 0
    v_add_u32 v148, 32768, v148
    v_lshrrev_b32 v3, 2, v0
    v_xor_b32 v3, v3, v0
    v_and_b32 v3, 4, v3
    v_cmp_eq_u32 vcc, 0, v3
    v_mov_b32 v3, 0x3f803f80
    s_nop 0
    v_cndmask_b32 v136, 0, v3, vcc
    v_mov_b32 v137, v136
    v_mov_b32 v138, v136
    v_mov_b32 v139, v136
    s_lshl_b32 s40, s61, 6
    v_xor_b32 v144, s40, v144
    v_add_u32 v148, s40, v148
    v_mov_b32 v39, v1
    v_and_b32 v2, 3, v0
    s_lshr_b32 s33, s3, 1
    s_lshl_b32 s33, s33, 4
    s_and_b32 s40, s32, 15
    s_add_u32 s33, s33, s40
    s_and_b32 s34, s3, 1
    s_lshl_b32 s34, s34, 1
    s_lshr_b32 s40, s32, 4
    s_add_u32 s34, s34, s40
    s_lshl_b32 s36, s3, 2
    s_and_b32 s40, s32, 3
    s_add_u32 s36, s36, s40
    s_lshr_b32 s37, s32, 2
    s_mul_i32 s38, s36, 163840
    s_add_u32 s38, s38, 2621440
    s_mul_i32 s60, s37, 20480
    v_lshlrev_b32 v37, 11, v0
    s_lshl_b32 s59, s63, 7
    s_add_u32 s59, s59, 19562496
    s_mul_i32 s41, s36, 20
    s_add_u32 s42, s41, 19
    s_lshr_b32 s41, s41, 7
    s_lshr_b32 s42, s42, 7
    s_lshl_b32 s41, 0x421, s41
    s_lshl_b32 s42, 0x421, s42
    s_or_b32 s56, s41, s42
    s_mov_b32 s57, 0
    s_bitset1_b32 s56, s63
    s_lshl_b32 s55, s3, 11
    s_add_u32 s55, s55, 19562496
    s_lshl_b32 s45, s63, 2
    s_add_u32 s45, s45, s61
    s_lshl_b32 s46, s62, 2
    s_add_u32 s46, s46, s61
    s_mul_i32 s47, s45, 640
    s_mul_i32 s45, s45, 2560
    s_mul_i32 s46, s46, 2560
    s_add_u32 s45, s45, 19628032
    s_add_u32 s46, s46, 19791872
    s_add_u32 s47, s47, 19587072
    v_lshlrev_b32 v4, 2, v0
    v_lshlrev_b32 v5, 4, v39
    buffer_load_dwordx2 v[40:41], v12, s[72:75], 0 offen offset:8 sc1
    s_barrier
    ds_read_b128 v[48:51], v140 offset:0
    ds_read_b64_tr_b16 v[64:65], v144 offset:0
    ds_read_b64_tr_b16 v[66:67], v144 offset:1024
    ds_read_b128 v[52:55], v141 offset:0
    ds_read_b64_tr_b16 v[68:69], v144 offset:4096
    ds_read_b64_tr_b16 v[70:71], v144 offset:5120
    ds_read_b128 v[56:59], v142 offset:0
    ds_read_b64_tr_b16 v[72:73], v144 offset:8192
    ds_read_b64_tr_b16 v[74:75], v144 offset:9216
    ds_read_b128 v[60:63], v143 offset:0
    ds_read_b64_tr_b16 v[76:77], v144 offset:12288
    ds_read_b64_tr_b16 v[78:79], v144 offset:13312
    s_waitcnt lgkmcnt(0)
    v_mfma_f32_16x16x32_bf16 v[132:135], v[136:139], v[64:67], 0
    v_mfma_f32_16x16x32_bf16 v[120:123], v[136:139], v[48:51], 0
    v_mfma_f32_4x4x4_16b_bf16 v[124:127], v[48:49], v[48:49], 0
    v_mfma_f32_4x4x4_16b_bf16 v[128:131], v[50:51], v[50:51], 0
    v_mfma_f32_16x16x32_bf16 v[132:135], v[136:139], v[68:71], v[132:135]
    v_mfma_f32_16x16x32_bf16 v[120:123], v[136:139], v[52:55], v[120:123]
    v_mfma_f32_4x4x4_16b_bf16 v[124:127], v[52:53], v[52:53], v[124:127]
    v_mfma_f32_4x4x4_16b_bf16 v[128:131], v[54:55], v[54:55], v[128:131]
    v_mfma_f32_16x16x32_bf16 v[132:135], v[136:139], v[72:75], v[132:135]
    v_mfma_f32_16x16x32_bf16 v[120:123], v[136:139], v[56:59], v[120:123]
    v_mfma_f32_4x4x4_16b_bf16 v[124:127], v[56:57], v[56:57], v[124:127]
    v_mfma_f32_4x4x4_16b_bf16 v[128:131], v[58:59], v[58:59], v[128:131]
    v_mfma_f32_16x16x32_bf16 v[132:135], v[136:139], v[76:79], v[132:135]
    v_mfma_f32_16x16x32_bf16 v[120:123], v[136:139], v[60:63], v[120:123]
    v_mfma_f32_4x4x4_16b_bf16 v[124:127], v[60:61], v[60:61], v[124:127]
    v_mfma_f32_4x4x4_16b_bf16 v[128:131], v[62:63], v[62:63], v[128:131]
    s_barrier
    ds_read_b128 v[48:51], v140 offset:16384
    ds_read_b64_tr_b16 v[64:65], v144 offset:16384
    ds_read_b64_tr_b16 v[66:67], v144 offset:17408
    ds_read_b128 v[52:55], v141 offset:16384
    ds_read_b64_tr_b16 v[68:69], v144 offset:20480
    ds_read_b64_tr_b16 v[70:71], v144 offset:21504
    ds_read_b128 v[56:59], v142 offset:16384
    ds_read_b64_tr_b16 v[72:73], v144 offset:24576
    ds_read_b64_tr_b16 v[74:75], v144 offset:25600
    ds_read_b128 v[60:63], v143 offset:16384
    ds_read_b64_tr_b16 v[76:77], v144 offset:28672
    ds_read_b64_tr_b16 v[78:79], v144 offset:29696
    s_waitcnt lgkmcnt(0)
    s_setprio 3
    v_mfma_f32_16x16x32_bf16 v[132:135], v[136:139], v[64:67], v[132:135]
    v_mfma_f32_16x16x32_bf16 v[120:123], v[136:139], v[48:51], v[120:123]
    v_mfma_f32_4x4x4_16b_bf16 v[124:127], v[48:49], v[48:49], v[124:127]
    v_mfma_f32_4x4x4_16b_bf16 v[128:131], v[50:51], v[50:51], v[128:131]
    v_mfma_f32_16x16x32_bf16 v[132:135], v[136:139], v[68:71], v[132:135]
    v_mfma_f32_16x16x32_bf16 v[120:123], v[136:139], v[52:55], v[120:123]
    v_mfma_f32_4x4x4_16b_bf16 v[124:127], v[52:53], v[52:53], v[124:127]
    v_mfma_f32_4x4x4_16b_bf16 v[128:131], v[54:55], v[54:55], v[128:131]
    v_mfma_f32_16x16x32_bf16 v[132:135], v[136:139], v[72:75], v[132:135]
    v_mfma_f32_16x16x32_bf16 v[120:123], v[136:139], v[56:59], v[120:123]
    v_mfma_f32_4x4x4_16b_bf16 v[124:127], v[56:57], v[56:57], v[124:127]
    v_mfma_f32_4x4x4_16b_bf16 v[128:131], v[58:59], v[58:59], v[128:131]
    v_mfma_f32_16x16x32_bf16 v[132:135], v[136:139], v[76:79], v[132:135]
    v_mfma_f32_16x16x32_bf16 v[120:123], v[136:139], v[60:63], v[120:123]
    v_mfma_f32_4x4x4_16b_bf16 v[124:127], v[60:61], v[60:61], v[124:127]
    v_mfma_f32_4x4x4_16b_bf16 v[128:131], v[62:63], v[62:63], v[128:131]
    s_nop 4
    v_add_f32 v124, v124, v128
    v_add_f32 v125, v125, v129
    v_add_f32 v126, v126, v130
    v_add_f32 v127, v127, v131
    v_cmp_eq_u32 vcc, 1, v2
    s_nop 1
    v_cndmask_b32 v124, v124, v125, vcc
    v_cmp_eq_u32 vcc, 2, v2
    s_nop 1
    v_cndmask_b32 v124, v124, v126, vcc
    v_cmp_eq_u32 vcc, 3, v2
    s_nop 1
    v_cndmask_b32 v124, v124, v127, vcc
    v_mov_b32 v128, v124
    s_nop 1
    v_permlane32_swap_b32 v124, v128
    v_add_f32 v124, v124, v128
    v_mov_b32 v121, v124
    s_setprio 0
    s_mov_b32 s49, 200000
M_TG:
    s_waitcnt vmcnt(0)
    v_cmp_eq_u32 vcc, 0, v40
    s_sub_u32 s49, s49, 1
    s_cbranch_vccz M_TGX
    buffer_load_dwordx2 v[40:41], v12, s[72:75], 0 offen offset:8 sc1
    s_cmp_lg_u32 s49, 0
    s_cbranch_scc1 M_TG
M_TGX:
    s_lshl_b32 s41, s44, 8
    s_add_u32 s40, s41, s45
    s_add_u32 s41, s41, s46
    v_mov_b32 v134, v40
    v_mov_b32 v135, v41
    v_mov_b32 v122, v40
    v_mov_b32 v123, v41
    s_mov_b32 exec_hi, 0
    buffer_store_dwordx4 v[132:135], v10, s[24:27], s40 offen sc1
    buffer_store_dwordx4 v[120:123], v10, s[24:27], s41 offen sc1
    s_mov_b32 exec_hi, -1
    s_cmp_lg_u32 s58, 781
    s_cbranch_scc1 M_S1
    s_mov_b32 s40, 19562496
    buffer_store_dword v12, v11, s[24:27], s40 offen sc1
    s_mov_b32 s40, 19570688
    buffer_store_dword v12, v11, s[24:27], s40 offen sc1
    s_mov_b32 s40, 19578880
    buffer_store_dword v12, v11, s[24:27], s40 offen sc1
M_S1:
    s_barrier
    s_cmp_lg_u32 s58, 781
    s_cbranch_scc1 M_SF
    s_waitcnt vmcnt(0)
    s_mov_b64 exec, 1
    buffer_store_dword v13, v12, s[72:75], 0 offen sc1
    s_mov_b64 exec, -1
M_SF:
    s_barrier
    s_bitcmp1_b32 s3, 0
    s_cbranch_scc1 S_T1
    s_lshr_b32 s41, s2, 1
    s_lshl_b32 s41, s41, 2
    s_add_u32 s41, s41, s61
    s_mov_b32 s16, s12
    s_mov_b32 s17, s13
    s_mov_b32 s18, 1966080
    s_mov_b32 s19, 0x20000
    s_mul_i32 s40, s41, 3840
    s_mov_b64 exec, 0x3fffffff
    buffer_load_dword v160, v11, s[16:19], s40 offen
    s_mov_b64 exec, -1
S_T1:
    s_barrier
    s_barrier
    s_barrier
    s_barrier
    buffer_load_dwordx4 v[80:83], v5, s[24:27], s45 offen offset:0 sc1
    buffer_load_dwordx4 v[100:103], v5, s[24:27], s46 offen offset:0 sc1
    buffer_load_dwordx4 v[84:87], v5, s[24:27], s45 offen offset:512 sc1
    buffer_load_dwordx4 v[104:107], v5, s[24:27], s46 offen offset:512 sc1
    buffer_load_dwordx4 v[88:91], v5, s[24:27], s45 offen offset:1024 sc1
    buffer_load_dwordx4 v[108:111], v5, s[24:27], s46 offen offset:1024 sc1
    buffer_load_dwordx4 v[92:95], v5, s[24:27], s45 offen offset:1536 sc1
    buffer_load_dwordx4 v[112:115], v5, s[24:27], s46 offen offset:1536 sc1
    buffer_load_dwordx4 v[96:99], v5, s[24:27], s45 offen offset:2048 sc1
    buffer_load_dwordx4 v[116:119], v5, s[24:27], s46 offen offset:2048 sc1
    s_cmp_lg_u32 s61, 0
    s_cbranch_scc1 M_S2
    buffer_load_dword v14, v12, s[72:75], 0 offen sc1
M_S2:
    s_barrier
    s_barrier
    s_mov_b32 s49, 200000
M_GA:
    s_sub_u32 s49, s49, 1
    s_waitcnt vmcnt(0)
    v_cmp_ne_u64 vcc, v[40:41], v[82:83]
    v_cmp_ne_u64 s[40:41], v[40:41], v[86:87]
    s_or_b64 vcc, vcc, s[40:41]
    v_cmp_ne_u64 s[40:41], v[40:41], v[90:91]
    s_or_b64 vcc, vcc, s[40:41]
    v_cmp_ne_u64 s[40:41], v[40:41], v[94:95]
    s_or_b64 vcc, vcc, s[40:41]
    v_cmp_ne_u64 s[40:41], v[40:41], v[98:99]
    s_or_b64 vcc, vcc, s[40:41]
    v_cmp_ne_u64 s[40:41], v[40:41], v[102:103]
    s_or_b64 vcc, vcc, s[40:41]
    v_cmp_ne_u64 s[40:41], v[40:41], v[106:107]
    s_or_b64 vcc, vcc, s[40:41]
    v_cmp_ne_u64 s[40:41], v[40:41], v[110:111]
    s_or_b64 vcc, vcc, s[40:41]
    v_cmp_ne_u64 s[40:41], v[40:41], v[114:115]
    s_or_b64 vcc, vcc, s[40:41]
    v_cmp_ne_u64 s[40:41], v[40:41], v[118:119]
    s_or_b64 vcc, vcc, s[40:41]
    s_cbranch_scc0 M_GAX
    buffer_load_dwordx4 v[80:83], v5, s[24:27], s45 offen offset:0 sc1
    buffer_load_dwordx4 v[100:103], v5, s[24:27], s46 offen offset:0 sc1
    buffer_load_dwordx4 v[84:87], v5, s[24:27], s45 offen offset:512 sc1
    buffer_load_dwordx4 v[104:107], v5, s[24:27], s46 offen offset:512 sc1
    buffer_load_dwordx4 v[88:91], v5, s[24:27], s45 offen offset:1024 sc1
    buffer_load_dwordx4 v[108:111], v5, s[24:27], s46 offen offset:1024 sc1
    buffer_load_dwordx4 v[92:95], v5, s[24:27], s45 offen offset:1536 sc1
    buffer_load_dwordx4 v[112:115], v5, s[24:27], s46 offen offset:1536 sc1
    buffer_load_dwordx4 v[96:99], v5, s[24:27], s45 offen offset:2048 sc1
    buffer_load_dwordx4 v[116:119], v5, s[24:27], s46 offen offset:2048 sc1
    s_cmp_lg_u32 s49, 0
    s_cbranch_scc1 M_GA
    s_waitcnt vmcnt(0)
M_GAX:
    v_add_f32 v80, v80, v84
    v_pk_add_f32 v[100:101], v[100:101], v[104:105]
    v_add_f32 v80, v80, v88
    v_pk_add_f32 v[100:101], v[100:101], v[108:109]
    v_add_f32 v80, v80, v92
    v_pk_add_f32 v[100:101], v[100:101], v[112:113]
    v_add_f32 v80, v80, v96
    v_pk_add_f32 v[100:101], v[100:101], v[116:117]
    v_mul_f32 v100, 0x3acccccd, v100
    v_mul_f32 v101, 0x3acccccd, v101
    v_fma_f32 v101, -v100, v100, v101
    v_max_f32 v101, 0, v101
    v_cvt_pk_bf16_f32 v101, v101, v101
    v_and_b32 v101, 0xffff0000, v101
    v_add_f32 v101, 0x3727c5ac, v101
    v_cvt_pk_bf16_f32 v101, v101, v101
    v_and_b32 v101, 0xffff0000, v101
    v_sqrt_f32 v101, v101
    v_cvt_pk_bf16_f32 v100, -v100, -v100
    v_cvt_pk_bf16_f32 v101, v101, v101
    v_and_b32 v101, 0xffff0000, v101
    v_rcp_f32 v101, v101
    v_cvt_pk_bf16_f32 v88, v80, v80
    v_and_b32 v89, 0xffff0000, v88
    v_sub_f32 v89, v80, v89
    v_cvt_pk_bf16_f32 v90, v80, v89
    v_and_b32 v88, 0xffff0000, v90
    v_sub_f32 v89, v89, v88
    v_cvt_pk_bf16_f32 v91, v89, 0
    s_lshl_b32 s40, s61, 8
    s_add_u32 s40, s40, 143360
    v_lshl_add_u32 v3, v39, 3, s40
    ds_write_b64 v3, v[90:91]
    s_lshl_b32 s40, s61, 7
    s_add_u32 s40, s40, 144384
    v_lshl_add_u32 v3, v39, 2, s40
    ds_write_b32 v3, v101
    ds_write_b32 v3, v100 offset:512
    s_waitcnt lgkmcnt(0)
    s_barrier
    s_cmp_lg_u32 s61, 0
    s_cbranch_scc1 M_S3X
    s_mov_b32 s49, 200000
M_S3:
    s_waitcnt vmcnt(0)
    v_cmp_ne_u16 vcc, 1, v14
    s_sub_u32 s49, s49, 1
    s_cbranch_vccz M_S3X
    buffer_load_dword v14, v12, s[72:75], 0 offen sc1
    s_cmp_lg_u32 s49, 0
    s_cbranch_scc1 M_S3
M_S3X:
    s_barrier
    ds_read_b64_tr_b16 v[48:49], v148 offset:0
    ds_read_b64_tr_b16 v[50:51], v148 offset:768
    ds_read_b64_tr_b16 v[52:53], v148 offset:3072
    ds_read_b64_tr_b16 v[54:55], v148 offset:3840
    ds_read_b64_tr_b16 v[56:57], v148 offset:6144
    ds_read_b64_tr_b16 v[58:59], v148 offset:6912
    ds_read_b64_tr_b16 v[60:61], v148 offset:9216
    ds_read_b64_tr_b16 v[62:63], v148 offset:9984
    ds_read_b64_tr_b16 v[64:65], v148 offset:16384
    ds_read_b64_tr_b16 v[66:67], v148 offset:17152
    ds_read_b64_tr_b16 v[68:69], v148 offset:19456
    ds_read_b64_tr_b16 v[70:71], v148 offset:20224
    ds_read_b64_tr_b16 v[72:73], v148 offset:22528
    ds_read_b64_tr_b16 v[74:75], v148 offset:23296
    ds_read_b64_tr_b16 v[76:77], v148 offset:25600
    ds_read_b64_tr_b16 v[78:79], v148 offset:26368
    s_add_u32 s44, s44, 4
    s_sub_u32 s41, s44, 10
    s_cmp_ge_u32 s44, 10
    s_cselect_b32 s44, s41, s44
    s_lshl_b32 s40, s44, 6
    s_add_u32 s40, s40, s47
    s_waitcnt lgkmcnt(0)
    v_mfma_f32_16x16x32_bf16 v[132:135], v[136:139], v[48:51], 0
    v_mfma_f32_16x16x32_bf16 v[132:135], v[136:139], v[52:55], v[132:135]
    v_mfma_f32_16x16x32_bf16 v[132:135], v[136:139], v[56:59], v[132:135]
    v_mfma_f32_16x16x32_bf16 v[132:135], v[136:139], v[60:63], v[132:135]
    v_mfma_f32_16x16x32_bf16 v[132:135], v[136:139], v[64:67], v[132:135]
    v_mfma_f32_16x16x32_bf16 v[132:135], v[136:139], v[68:71], v[132:135]
    v_mfma_f32_16x16x32_bf16 v[132:135], v[136:139], v[72:75], v[132:135]
    v_mfma_f32_16x16x32_bf16 v[132:135], v[136:139], v[76:79], v[132:135]
    s_mov_b32 exec_hi, 0
    s_nop 6
    buffer_store_dword v132, v4, s[24:27], s40 offen sc1
    s_mov_b32 exec_hi, -1
    s_barrier
    s_waitcnt vmcnt(0)
    s_barrier
    s_bitcmp1_b32 s3, 0
    s_cbranch_scc1 S_T2
    s_lshr_b32 s41, s2, 1
    s_lshl_b32 s41, s41, 2
    s_add_u32 s41, s41, s61
    s_mov_b32 s16, s14
    s_mov_b32 s17, s15
    s_mov_b32 s18, 1966080
    s_mov_b32 s19, 0x20000
    s_mul_i32 s40, s41, 3840
    s_mov_b64 exec, 0x3fffffff
    buffer_load_dword v160, v11, s[16:19], s40 offen
    s_mov_b32 s16, s8
    s_mov_b32 s17, s9
    s_mov_b32 s18, 819200
    s_mov_b32 s19, 0x20000
    s_mul_i32 s40, s41, 1792
    s_mov_b64 exec, 0x3fff
    buffer_load_dword v160, v11, s[16:19], s40 offen
    s_mov_b64 exec, -1
S_T2:
    s_cmp_lg_u32 s61, 0
    s_cbranch_scc1 M_S5
    s_mov_b64 exec, 0xff
    buffer_atomic_add v13, v37, s[24:27], s59 offen sc1
    s_mov_b64 exec, -1
M_S5:
    s_barrier
    s_barrier
    s_barrier
    s_barrier
    s_barrier
    s_cmp_lg_u32 s61, 0
    s_cbranch_scc1 M_S9
    s_mov_b64 exec, s[56:57]
    buffer_load_dword v14, v11, s[24:27], s55 offen sc1
    s_mov_b64 exec, -1
M_S9:
    s_cmp_lg_u32 s61, 0
    s_cbranch_scc1 M_S8
    s_mov_b64 exec, s[56:57]
    s_mov_b32 s49, 200000
M_S7:
    s_waitcnt vmcnt(0)
    v_cmp_ne_u16 vcc, 16, v14
    s_sub_u32 s49, s49, 1
    s_cbranch_vccz M_S7X
    buffer_load_dword v14, v11, s[24:27], s55 offen sc1
    s_cmp_lg_u32 s49, 0
    s_cbranch_scc1 M_S7
M_S7X:
    s_mov_b64 exec, -1
M_S8:
    s_barrier
    v_lshlrev_b32 v1, 4, v0
    s_lshl_b32 s39, s37, 3
    s_add_u32 s39, s39, s35
    s_mul_i32 s40, s36, 81920
    s_mul_i32 s41, s39, 1280
    s_add_u32 s40, s40, s41
    v_and_b32 v4, 31, v0
    v_lshlrev_b32 v5, 3, v4
    s_lshl_b32 s41, s35, 10
    buffer_load_dwordx4 v[124:127], v1, s[24:27], s40 offen sc1
    buffer_load_dwordx2 v[122:123], v5, s[24:27], s40 offen offset:1024 sc1
    s_add_u32 s40, s38, s60
    v_lshlrev_b32 v7, 3, v0
    buffer_load_dwordx4 v[112:115], v1, s[24:27], s40 offen sc1
    buffer_load_dwordx4 v[116:119], v1, s[24:27], s40 offen offset:1024 sc1
    buffer_load_dwordx2 v[120:121], v7, s[24:27], s40 offen offset:2048 sc1
    s_mov_b32 m0, s41
    s_add_u32 s42, s41, s60
    s_sub_u32 s43, s42, 163840
    s_cmp_ge_u32 s42, 163840
    s_cselect_b32 s42, s43, s42
    s_add_u32 s42, s42, s38
    buffer_load_dwordx4 v1, s[24:27], s42 offen sc1 lds
    s_add_u32 s41, s41, 8192
    s_mov_b32 m0, s41
    s_add_u32 s42, s41, s60
    s_sub_u32 s43, s42, 163840
    s_cmp_ge_u32 s42, 163840
    s_cselect_b32 s42, s43, s42
    s_add_u32 s42, s42, s38
    buffer_load_dwordx4 v1, s[24:27], s42 offen sc1 lds
    s_add_u32 s41, s41, 8192
    s_barrier
M_ATT:
    s_mov_b32 m0, s41
    s_add_u32 s42, s41, s60
    s_sub_u32 s43, s42, 163840
    s_cmp_ge_u32 s42, 163840
    s_cselect_b32 s42, s43, s42
    s_add_u32 s42, s42, s38
    buffer_load_dwordx4 v1, s[24:27], s42 offen sc1 lds
    s_add_u32 s41, s41, 8192
    s_mov_b32 m0, s41
    s_add_u32 s42, s41, s60
    s_sub_u32 s43, s42, 163840
    s_cmp_ge_u32 s42, 163840
    s_cselect_b32 s42, s43, s42
    s_add_u32 s42, s42, s38
    buffer_load_dwordx4 v1, s[24:27], s42 offen sc1 lds
    s_add_u32 s41, s41, 8192
    s_mov_b32 m0, s41
    s_add_u32 s42, s41, s60
    s_sub_u32 s43, s42, 163840
    s_cmp_ge_u32 s42, 163840
    s_cselect_b32 s42, s43, s42
    s_add_u32 s42, s42, s38
    buffer_load_dwordx4 v1, s[24:27], s42 offen sc1 lds
    s_add_u32 s41, s41, 8192
    v_add_u32 v2, 4096, v1
    v_mov_b32 v6, v1
    v_add_u32 v7, 2048, v7
    v_lshrrev_b32 v3, 5, v0
    v_mul_u32_u24 v8, 320, v3
    v_lshl_add_u32 v8, v4, 4, v8
    v_add_u32 v8, 2560, v8
    s_mov_b32 s44, 0x000fffff
    s_mov_b32 s45, 0x000fffff
    v_and_b32 v12, 27, v0
    v_cmp_eq_u32 vcc, 24, v12
    v_mov_b32 v12, 0x3f803f80
    s_nop 0
    v_cndmask_b32 v128, 0, v12, vcc
    v_mov_b32 v129, v128
    v_mov_b32 v130, v128
    v_mov_b32 v131, v128
    v_mov_b32 v132, v128
    v_mov_b32 v133, v128
    v_mov_b32 v134, v128
    v_mov_b32 v135, v128
    v_mov_b32 v136, v128
    v_mov_b32 v137, v128
    v_mov_b32 v138, v128
    v_mov_b32 v139, v128
    v_mov_b32 v140, v128
    v_mov_b32 v141, v128
    v_mov_b32 v142, v128
    v_mov_b32 v143, v128
    v_mov_b32 v144, v128
    v_mov_b32 v145, v128
    v_mov_b32 v146, v128
    v_mov_b32 v147, v128
    v_mov_b32 v148, v128
    v_mov_b32 v149, v128
    v_mov_b32 v150, v128
    v_mov_b32 v151, v128
    v_mov_b32 v152, v128
    v_mov_b32 v153, v128
    v_mov_b32 v154, v128
    v_mov_b32 v155, v128
    v_mov_b32 v156, v128
    v_mov_b32 v157, v128
    v_mov_b32 v158, v128
    v_mov_b32 v159, v128
    s_movk_i32 s46, 656
    s_lshl_b32 s48, s3, 11
    s_add_u32 s48, s48, 19562496
    v_lshlrev_b32 v14, 7, v0
    s_mov_b32 s16, s4
    s_mov_b32 s17, s5
    s_mov_b32 s18, 2621440
    s_mov_b32 s19, 0x20000
    s_mov_b32 s20, s64
    s_mov_b32 s21, s65
    s_mov_b32 s22, 2621440
    s_mov_b32 s23, 0x20000
    v_mov_b32 v96, 0
    v_mov_b32 v97, 0
    v_mov_b32 v98, 0
    v_mov_b32 v99, 0
    v_mov_b32 v100, 0
    v_mov_b32 v101, 0
    v_mov_b32 v102, 0
    v_mov_b32 v103, 0
    v_mov_b32 v104, 0
    v_mov_b32 v105, 0
    v_mov_b32 v106, 0
    v_mov_b32 v107, 0
    v_mov_b32 v108, 0
    v_mov_b32 v109, 0
    v_mov_b32 v110, 0
    v_mov_b32 v111, 0
    v_mov_b32 v72, 0
    v_mov_b32 v73, 0
    v_mov_b32 v74, 0
    v_mov_b32 v75, 0
    s_waitcnt vmcnt(5)
    v_mfma_f32_32x32x16_bf16 v[16:31], v[112:115], v[124:127], 0
    v_mfma_f32_32x32x16_bf16 v[32:47], v[116:119], v[124:127], 0
    s_nop 9
    v_mfma_f32_32x32x4_2b_bf16 v[16:47], v[120:121], v[122:123], v[16:47]
    s_nop 15
    s_nop 3
    v_max3_f32 v12, v16, v17, v18
    v_max_f32 v12, v12, v19
    v_max3_f32 v12, v20, v21, v12
    v_max3_f32 v12, v22, v23, v12
    v_max3_f32 v12, v24, v25, v12
    v_max3_f32 v12, v26, v27, v12
    v_max3_f32 v12, v28, v29, v12
    v_max3_f32 v12, v30, v31, v12
    v_max3_f32 v12, v32, v33, v12
    v_max3_f32 v12, v34, v35, v12
    v_max3_f32 v12, v36, v37, v12
    v_max3_f32 v12, v38, v39, v12
    v_max3_f32 v12, v40, v41, v12
    v_max3_f32 v12, v42, v43, v12
    v_max3_f32 v12, v44, v45, v12
    v_max3_f32 v12, v46, v47, v12
    v_mov_b32 v13, v12
    s_nop 1
    v_permlane32_swap_b32 v12, v13
    v_max_f32 v12, v12, v13
    v_sub_f32 v80, 0, v12
    v_mov_b32 v81, v80
    v_mov_b32 v82, v80
    v_mov_b32 v83, v80
    v_mov_b32 v84, v80
    v_mov_b32 v85, v80
    v_mov_b32 v86, v80
    v_mov_b32 v87, v80
    v_mov_b32 v88, v80
    v_mov_b32 v89, v80
    v_mov_b32 v90, v80
    v_mov_b32 v91, v80
    v_mov_b32 v92, v80
    v_mov_b32 v93, v80
    v_mov_b32 v94, v80
    v_mov_b32 v95, v80
    v_mov_b32 v9, v6
    v_mov_b32 v10, v7
    v_mov_b32 v11, v8
    v_add_f32 v16, v80, v16
    v_add_f32 v17, v80, v17
    v_add_f32 v18, v80, v18
    v_add_f32 v19, v80, v19
    v_add_f32 v20, v80, v20
    v_add_f32 v21, v80, v21
    v_add_f32 v22, v80, v22
    v_add_f32 v23, v80, v23
    v_add_f32 v24, v80, v24
    v_add_f32 v25, v80, v25
    v_add_f32 v26, v80, v26
    v_add_f32 v27, v80, v27
    v_add_f32 v28, v80, v28
    v_add_f32 v29, v80, v29
    v_add_f32 v30, v80, v30
    v_add_f32 v31, v80, v31
    v_add_f32 v32, v80, v32
    v_add_f32 v33, v80, v33
    v_add_f32 v34, v80, v34
    v_add_f32 v35, v80, v35
    v_add_f32 v36, v80, v36
    v_add_f32 v37, v80, v37
    v_add_f32 v38, v80, v38
    v_add_f32 v39, v80, v39
    v_add_f32 v40, v80, v40
    v_add_f32 v41, v80, v41
    v_add_f32 v42, v80, v42
    v_add_f32 v43, v80, v43
    v_add_f32 v44, v80, v44
    v_add_f32 v45, v80, v45
    v_add_f32 v46, v80, v46
    v_add_f32 v47, v80, v47
    s_setprio 2
    s_waitcnt vmcnt(0)
    s_barrier
    ds_read_b128 v[112:115], v9 offset:5120
    ds_read_b128 v[116:119], v9 offset:6144
    ds_read_b64 v[120:121], v10 offset:5120
    s_mov_b64 exec, s[44:45]
    ds_read_b128 v[128:131], v11 offset:0
    ds_read_b128 v[132:135], v11 offset:640
    ds_read_b128 v[136:139], v11 offset:1280
    ds_read_b128 v[140:143], v11 offset:1920
    s_mov_b64 exec, -1
    s_mov_b32 s49, 4
    s_nop 7
A_LOOP:
    s_waitcnt lgkmcnt(0)
    v_mfma_f32_32x32x16_bf16 v[48:63], v[112:115], v[124:127], v[80:95]
    ds_read_b128 v[112:115], v9 offset:10240
    v_exp_f32 v16, v16
    v_exp_f32 v17, v17
    v_exp_f32 v18, v18
    v_exp_f32 v19, v19
    v_mfma_f32_32x32x16_bf16 v[96:111], v[156:159], v[72:75], v[96:111]
    s_mov_b64 exec, s[44:45]
    ds_read_b128 v[144:147], v11 offset:5120
    ds_read_b128 v[148:151], v11 offset:5760
    ds_read_b128 v[152:155], v11 offset:6400
    ds_read_b128 v[156:159], v11 offset:7040
    s_mov_b64 exec, -1
    v_exp_f32 v20, v20
    v_exp_f32 v21, v21
    v_exp_f32 v22, v22
    v_exp_f32 v23, v23
    v_cvt_pk_bf16_f32 v16, v16, v17
    v_cvt_pk_bf16_f32 v17, v18, v19
    v_mfma_f32_32x32x16_bf16 v[64:79], v[116:119], v[124:127], v[80:95]
    ds_read_b128 v[116:119], v9 offset:11264
    v_cvt_pk_bf16_f32 v18, v20, v21
    v_cvt_pk_bf16_f32 v19, v22, v23
    v_exp_f32 v24, v24
    v_exp_f32 v25, v25
    v_exp_f32 v26, v26
    v_mfma_f32_32x32x16_bf16 v[96:111], v[128:131], v[16:19], v[96:111]
    v_exp_f32 v27, v27
    v_exp_f32 v28, v28
    v_exp_f32 v29, v29
    v_exp_f32 v30, v30
    v_exp_f32 v31, v31
    v_cvt_pk_bf16_f32 v24, v24, v25
    v_cvt_pk_bf16_f32 v25, v26, v27
    v_mfma_f32_32x32x4_2b_bf16 v[48:79], v[120:121], v[122:123], v[48:79]
    ds_read_b64 v[120:121], v10 offset:10240
    v_cvt_pk_bf16_f32 v26, v28, v29
    v_cvt_pk_bf16_f32 v27, v30, v31
    v_exp_f32 v32, v32
    v_exp_f32 v33, v33
    v_exp_f32 v34, v34
    v_exp_f32 v35, v35
    v_exp_f32 v36, v36
    v_exp_f32 v37, v37
    v_exp_f32 v38, v38
    v_mfma_f32_32x32x16_bf16 v[96:111], v[132:135], v[24:27], v[96:111]
    v_exp_f32 v39, v39
    v_cvt_pk_bf16_f32 v32, v32, v33
    v_cvt_pk_bf16_f32 v33, v34, v35
    v_cvt_pk_bf16_f32 v34, v36, v37
    v_exp_f32 v40, v40
    v_cvt_pk_bf16_f32 v35, v38, v39
    v_exp_f32 v41, v41
    v_exp_f32 v42, v42
    v_mfma_f32_32x32x16_bf16 v[96:111], v[136:139], v[32:35], v[96:111]
    v_exp_f32 v43, v43
    v_exp_f32 v44, v44
    v_exp_f32 v45, v45
    v_exp_f32 v46, v46
    v_exp_f32 v47, v47
    v_cvt_pk_bf16_f32 v40, v40, v41
    v_cvt_pk_bf16_f32 v41, v42, v43
    v_cvt_pk_bf16_f32 v42, v44, v45
    v_cvt_pk_bf16_f32 v43, v46, v47
    s_waitcnt lgkmcnt(0)
    v_mfma_f32_32x32x16_bf16 v[16:31], v[112:115], v[124:127], v[80:95]
    s_cmp_lg_u32 s49, 3
    s_cbranch_scc1 A_PR
A_PRR:
    ds_read_b128 v[112:115], v9 offset:15360
    v_exp_f32 v48, v48
    v_exp_f32 v49, v49
    v_exp_f32 v50, v50
    v_exp_f32 v51, v51
    v_mfma_f32_32x32x16_bf16 v[96:111], v[140:143], v[40:43], v[96:111]
    s_mov_b64 exec, s[44:45]
    ds_read_b128 v[128:131], v11 offset:10240
    ds_read_b128 v[132:135], v11 offset:10880
    ds_read_b128 v[136:139], v11 offset:11520
    ds_read_b128 v[140:143], v11 offset:12160
    s_mov_b64 exec, -1
    v_exp_f32 v52, v52
    v_exp_f32 v53, v53
    v_exp_f32 v54, v54
    v_exp_f32 v55, v55
    v_cvt_pk_bf16_f32 v48, v48, v49
    v_cvt_pk_bf16_f32 v49, v50, v51
    v_mfma_f32_32x32x16_bf16 v[32:47], v[116:119], v[124:127], v[80:95]
    ds_read_b128 v[116:119], v9 offset:16384
    v_cvt_pk_bf16_f32 v50, v52, v53
    v_cvt_pk_bf16_f32 v51, v54, v55
    v_exp_f32 v56, v56
    v_exp_f32 v57, v57
    v_exp_f32 v58, v58
    v_mfma_f32_32x32x16_bf16 v[96:111], v[144:147], v[48:51], v[96:111]
    v_exp_f32 v59, v59
    v_exp_f32 v60, v60
    v_exp_f32 v61, v61
    v_exp_f32 v62, v62
    v_exp_f32 v63, v63
    v_cvt_pk_bf16_f32 v56, v56, v57
    v_cvt_pk_bf16_f32 v57, v58, v59
    v_mfma_f32_32x32x4_2b_bf16 v[16:47], v[120:121], v[122:123], v[16:47]
    ds_read_b64 v[120:121], v10 offset:15360
    v_cvt_pk_bf16_f32 v58, v60, v61
    v_cvt_pk_bf16_f32 v59, v62, v63
    v_exp_f32 v64, v64
    v_exp_f32 v65, v65
    v_exp_f32 v66, v66
    v_exp_f32 v67, v67
    v_exp_f32 v68, v68
    v_exp_f32 v69, v69
    v_exp_f32 v70, v70
    v_mfma_f32_32x32x16_bf16 v[96:111], v[148:151], v[56:59], v[96:111]
    v_exp_f32 v71, v71
    v_cvt_pk_bf16_f32 v64, v64, v65
    v_cvt_pk_bf16_f32 v65, v66, v67
    v_cvt_pk_bf16_f32 v66, v68, v69
    v_exp_f32 v72, v72
    v_cvt_pk_bf16_f32 v67, v70, v71
    v_exp_f32 v73, v73
    v_exp_f32 v74, v74
    v_mfma_f32_32x32x16_bf16 v[96:111], v[152:155], v[64:67], v[96:111]
    v_exp_f32 v75, v75
    v_exp_f32 v76, v76
    v_exp_f32 v77, v77
    v_exp_f32 v78, v78
    v_exp_f32 v79, v79
    v_cvt_pk_bf16_f32 v72, v72, v73
    v_cvt_pk_bf16_f32 v73, v74, v75
    v_cvt_pk_bf16_f32 v74, v76, v77
    v_cvt_pk_bf16_f32 v75, v78, v79
    s_waitcnt lgkmcnt(0)
    v_mfma_f32_32x32x16_bf16 v[48:63], v[112:115], v[124:127], v[80:95]
    ds_read_b128 v[112:115], v9 offset:20480
    v_exp_f32 v16, v16
    v_exp_f32 v17, v17
    v_exp_f32 v18, v18
    v_exp_f32 v19, v19
    v_mfma_f32_32x32x16_bf16 v[96:111], v[156:159], v[72:75], v[96:111]
    s_mov_b64 exec, s[44:45]
    ds_read_b128 v[144:147], v11 offset:15360
    ds_read_b128 v[148:151], v11 offset:16000
    ds_read_b128 v[152:155], v11 offset:16640
    ds_read_b128 v[156:159], v11 offset:17280
    s_mov_b64 exec, -1
    v_exp_f32 v20, v20
    v_exp_f32 v21, v21
    v_exp_f32 v22, v22
    v_exp_f32 v23, v23
    v_cvt_pk_bf16_f32 v16, v16, v17
    v_cvt_pk_bf16_f32 v17, v18, v19
    v_mfma_f32_32x32x16_bf16 v[64:79], v[116:119], v[124:127], v[80:95]
    ds_read_b128 v[116:119], v9 offset:21504
    v_cvt_pk_bf16_f32 v18, v20, v21
    v_cvt_pk_bf16_f32 v19, v22, v23
    v_exp_f32 v24, v24
    v_exp_f32 v25, v25
    v_exp_f32 v26, v26
    v_mfma_f32_32x32x16_bf16 v[96:111], v[128:131], v[16:19], v[96:111]
    v_exp_f32 v27, v27
    v_exp_f32 v28, v28
    v_exp_f32 v29, v29
    v_exp_f32 v30, v30
    v_exp_f32 v31, v31
    v_cvt_pk_bf16_f32 v24, v24, v25
    v_cvt_pk_bf16_f32 v25, v26, v27
    v_mfma_f32_32x32x4_2b_bf16 v[48:79], v[120:121], v[122:123], v[48:79]
    ds_read_b64 v[120:121], v10 offset:20480
    v_cvt_pk_bf16_f32 v26, v28, v29
    v_cvt_pk_bf16_f32 v27, v30, v31
    v_exp_f32 v32, v32
    v_exp_f32 v33, v33
    v_exp_f32 v34, v34
    v_exp_f32 v35, v35
    v_exp_f32 v36, v36
    v_exp_f32 v37, v37
    v_exp_f32 v38, v38
    v_mfma_f32_32x32x16_bf16 v[96:111], v[132:135], v[24:27], v[96:111]
    v_exp_f32 v39, v39
    v_cvt_pk_bf16_f32 v32, v32, v33
    v_cvt_pk_bf16_f32 v33, v34, v35
    v_cvt_pk_bf16_f32 v34, v36, v37
    v_exp_f32 v40, v40
    v_cvt_pk_bf16_f32 v35, v38, v39
    v_exp_f32 v41, v41
    v_exp_f32 v42, v42
    v_mfma_f32_32x32x16_bf16 v[96:111], v[136:139], v[32:35], v[96:111]
    v_exp_f32 v43, v43
    v_exp_f32 v44, v44
    v_exp_f32 v45, v45
    v_exp_f32 v46, v46
    v_exp_f32 v47, v47
    v_cvt_pk_bf16_f32 v40, v40, v41
    v_cvt_pk_bf16_f32 v41, v42, v43
    v_cvt_pk_bf16_f32 v42, v44, v45
    v_cvt_pk_bf16_f32 v43, v46, v47
    s_waitcnt lgkmcnt(0)
    v_mfma_f32_32x32x16_bf16 v[16:31], v[112:115], v[124:127], v[80:95]
    ds_read_b128 v[112:115], v9 offset:25600
    v_exp_f32 v48, v48
    v_exp_f32 v49, v49
    v_exp_f32 v50, v50
    v_exp_f32 v51, v51
    v_mfma_f32_32x32x16_bf16 v[96:111], v[140:143], v[40:43], v[96:111]
    s_mov_b64 exec, s[44:45]
    ds_read_b128 v[128:131], v11 offset:20480
    ds_read_b128 v[132:135], v11 offset:21120
    ds_read_b128 v[136:139], v11 offset:21760
    ds_read_b128 v[140:143], v11 offset:22400
    s_mov_b64 exec, -1
    v_exp_f32 v52, v52
    v_exp_f32 v53, v53
    v_exp_f32 v54, v54
    v_exp_f32 v55, v55
    v_cvt_pk_bf16_f32 v48, v48, v49
    v_cvt_pk_bf16_f32 v49, v50, v51
    v_mfma_f32_32x32x16_bf16 v[32:47], v[116:119], v[124:127], v[80:95]
    ds_read_b128 v[116:119], v9 offset:26624
    v_cvt_pk_bf16_f32 v50, v52, v53
    v_cvt_pk_bf16_f32 v51, v54, v55
    v_exp_f32 v56, v56
    v_exp_f32 v57, v57
    v_exp_f32 v58, v58
    v_mfma_f32_32x32x16_bf16 v[96:111], v[144:147], v[48:51], v[96:111]
    v_exp_f32 v59, v59
    v_exp_f32 v60, v60
    v_exp_f32 v61, v61
    v_exp_f32 v62, v62
    v_exp_f32 v63, v63
    v_cvt_pk_bf16_f32 v56, v56, v57
    v_cvt_pk_bf16_f32 v57, v58, v59
    v_mfma_f32_32x32x4_2b_bf16 v[16:47], v[120:121], v[122:123], v[16:47]
    ds_read_b64 v[120:121], v10 offset:25600
    v_cvt_pk_bf16_f32 v58, v60, v61
    v_cvt_pk_bf16_f32 v59, v62, v63
    v_exp_f32 v64, v64
    v_exp_f32 v65, v65
    v_exp_f32 v66, v66
    v_exp_f32 v67, v67
    v_exp_f32 v68, v68
    v_exp_f32 v69, v69
    v_exp_f32 v70, v70
    v_mfma_f32_32x32x16_bf16 v[96:111], v[148:151], v[56:59], v[96:111]
    v_exp_f32 v71, v71
    v_cvt_pk_bf16_f32 v64, v64, v65
    v_cvt_pk_bf16_f32 v65, v66, v67
    v_cvt_pk_bf16_f32 v66, v68, v69
    v_exp_f32 v72, v72
    v_cvt_pk_bf16_f32 v67, v70, v71
    v_exp_f32 v73, v73
    v_exp_f32 v74, v74
    v_mfma_f32_32x32x16_bf16 v[96:111], v[152:155], v[64:67], v[96:111]
    v_exp_f32 v75, v75
    v_exp_f32 v76, v76
    v_exp_f32 v77, v77
    v_exp_f32 v78, v78
    v_exp_f32 v79, v79
    v_cvt_pk_bf16_f32 v72, v72, v73
    v_cvt_pk_bf16_f32 v73, v74, v75
    v_cvt_pk_bf16_f32 v74, v76, v77
    v_cvt_pk_bf16_f32 v75, v78, v79
    s_waitcnt lgkmcnt(0)
    v_mfma_f32_32x32x16_bf16 v[48:63], v[112:115], v[124:127], v[80:95]
    ds_read_b128 v[112:115], v9 offset:30720
    v_exp_f32 v16, v16
    v_exp_f32 v17, v17
    v_exp_f32 v18, v18
    v_exp_f32 v19, v19
    v_mfma_f32_32x32x16_bf16 v[96:111], v[156:159], v[72:75], v[96:111]
    s_mov_b64 exec, s[44:45]
    ds_read_b128 v[144:147], v11 offset:25600
    ds_read_b128 v[148:151], v11 offset:26240
    ds_read_b128 v[152:155], v11 offset:26880
    ds_read_b128 v[156:159], v11 offset:27520
    s_mov_b64 exec, -1
    v_exp_f32 v20, v20
    v_exp_f32 v21, v21
    v_exp_f32 v22, v22
    v_exp_f32 v23, v23
    v_cvt_pk_bf16_f32 v16, v16, v17
    v_cvt_pk_bf16_f32 v17, v18, v19
    v_mfma_f32_32x32x16_bf16 v[64:79], v[116:119], v[124:127], v[80:95]
    ds_read_b128 v[116:119], v9 offset:31744
    v_cvt_pk_bf16_f32 v18, v20, v21
    v_cvt_pk_bf16_f32 v19, v22, v23
    v_exp_f32 v24, v24
    v_exp_f32 v25, v25
    v_exp_f32 v26, v26
    v_mfma_f32_32x32x16_bf16 v[96:111], v[128:131], v[16:19], v[96:111]
    v_exp_f32 v27, v27
    v_exp_f32 v28, v28
    v_exp_f32 v29, v29
    v_exp_f32 v30, v30
    v_exp_f32 v31, v31
    v_cvt_pk_bf16_f32 v24, v24, v25
    v_cvt_pk_bf16_f32 v25, v26, v27
    v_mfma_f32_32x32x4_2b_bf16 v[48:79], v[120:121], v[122:123], v[48:79]
    ds_read_b64 v[120:121], v10 offset:30720
    v_cvt_pk_bf16_f32 v26, v28, v29
    v_cvt_pk_bf16_f32 v27, v30, v31
    v_exp_f32 v32, v32
    v_exp_f32 v33, v33
    v_exp_f32 v34, v34
    v_exp_f32 v35, v35
    v_exp_f32 v36, v36
    v_exp_f32 v37, v37
    v_exp_f32 v38, v38
    v_mfma_f32_32x32x16_bf16 v[96:111], v[132:135], v[24:27], v[96:111]
    v_exp_f32 v39, v39
    v_cvt_pk_bf16_f32 v32, v32, v33
    v_cvt_pk_bf16_f32 v33, v34, v35
    v_cvt_pk_bf16_f32 v34, v36, v37
    v_exp_f32 v40, v40
    v_cvt_pk_bf16_f32 v35, v38, v39
    v_exp_f32 v41, v41
    v_exp_f32 v42, v42
    v_mfma_f32_32x32x16_bf16 v[96:111], v[136:139], v[32:35], v[96:111]
    v_exp_f32 v43, v43
    v_exp_f32 v44, v44
    v_exp_f32 v45, v45
    v_exp_f32 v46, v46
    v_exp_f32 v47, v47
    v_cvt_pk_bf16_f32 v40, v40, v41
    v_cvt_pk_bf16_f32 v41, v42, v43
    v_cvt_pk_bf16_f32 v42, v44, v45
    v_cvt_pk_bf16_f32 v43, v46, v47
    s_waitcnt lgkmcnt(0)
    v_mfma_f32_32x32x16_bf16 v[16:31], v[112:115], v[124:127], v[80:95]
    ds_read_b128 v[112:115], v9 offset:35840
    v_exp_f32 v48, v48
    v_exp_f32 v49, v49
    v_exp_f32 v50, v50
    v_exp_f32 v51, v51
    v_mfma_f32_32x32x16_bf16 v[96:111], v[140:143], v[40:43], v[96:111]
    s_mov_b64 exec, s[44:45]
    ds_read_b128 v[128:131], v11 offset:30720
    ds_read_b128 v[132:135], v11 offset:31360
    ds_read_b128 v[136:139], v11 offset:32000
    ds_read_b128 v[140:143], v11 offset:32640
    s_mov_b64 exec, -1
    v_exp_f32 v52, v52
    v_exp_f32 v53, v53
    v_exp_f32 v54, v54
    v_exp_f32 v55, v55
    v_cvt_pk_bf16_f32 v48, v48, v49
    v_cvt_pk_bf16_f32 v49, v50, v51
    v_mfma_f32_32x32x16_bf16 v[32:47], v[116:119], v[124:127], v[80:95]
    ds_read_b128 v[116:119], v9 offset:36864
    v_cvt_pk_bf16_f32 v50, v52, v53
    v_cvt_pk_bf16_f32 v51, v54, v55
    v_exp_f32 v56, v56
    v_exp_f32 v57, v57
    v_exp_f32 v58, v58
    v_mfma_f32_32x32x16_bf16 v[96:111], v[144:147], v[48:51], v[96:111]
    v_exp_f32 v59, v59
    v_exp_f32 v60, v60
    v_exp_f32 v61, v61
    v_exp_f32 v62, v62
    v_exp_f32 v63, v63
    v_cvt_pk_bf16_f32 v56, v56, v57
    v_cvt_pk_bf16_f32 v57, v58, v59
    v_mfma_f32_32x32x4_2b_bf16 v[16:47], v[120:121], v[122:123], v[16:47]
    ds_read_b64 v[120:121], v10 offset:35840
    v_cvt_pk_bf16_f32 v58, v60, v61
    v_cvt_pk_bf16_f32 v59, v62, v63
    v_exp_f32 v64, v64
    v_exp_f32 v65, v65
    v_exp_f32 v66, v66
    v_exp_f32 v67, v67
    v_exp_f32 v68, v68
    v_exp_f32 v69, v69
    v_exp_f32 v70, v70
    v_mfma_f32_32x32x16_bf16 v[96:111], v[148:151], v[56:59], v[96:111]
    v_exp_f32 v71, v71
    v_cvt_pk_bf16_f32 v64, v64, v65
    v_cvt_pk_bf16_f32 v65, v66, v67
    v_cvt_pk_bf16_f32 v66, v68, v69
    v_exp_f32 v72, v72
    v_cvt_pk_bf16_f32 v67, v70, v71
    v_exp_f32 v73, v73
    v_exp_f32 v74, v74
    v_mfma_f32_32x32x16_bf16 v[96:111], v[152:155], v[64:67], v[96:111]
    v_exp_f32 v75, v75
    v_exp_f32 v76, v76
    v_exp_f32 v77, v77
    v_exp_f32 v78, v78
    v_exp_f32 v79, v79
    v_cvt_pk_bf16_f32 v72, v72, v73
    v_cvt_pk_bf16_f32 v73, v74, v75
    v_cvt_pk_bf16_f32 v74, v76, v77
    v_cvt_pk_bf16_f32 v75, v78, v79
    s_waitcnt lgkmcnt(0)
    v_mfma_f32_32x32x16_bf16 v[48:63], v[112:115], v[124:127], v[80:95]
    s_cmp_eq_u32 s49, 4
    s_cbranch_scc1 A_B2
A_B2R:
    ds_read_b128 v[112:115], v9 offset:40960
    v_exp_f32 v16, v16
    v_exp_f32 v17, v17
    v_exp_f32 v18, v18
    v_exp_f32 v19, v19
    v_mfma_f32_32x32x16_bf16 v[96:111], v[156:159], v[72:75], v[96:111]
    s_mov_b64 exec, s[44:45]
    ds_read_b128 v[144:147], v11 offset:35840
    ds_read_b128 v[148:151], v11 offset:36480
    ds_read_b128 v[152:155], v11 offset:37120
    ds_read_b128 v[156:159], v11 offset:37760
    s_mov_b64 exec, -1
    v_exp_f32 v20, v20
    v_exp_f32 v21, v21
    v_exp_f32 v22, v22
    v_exp_f32 v23, v23
    v_cvt_pk_bf16_f32 v16, v16, v17
    v_cvt_pk_bf16_f32 v17, v18, v19
    v_mfma_f32_32x32x16_bf16 v[64:79], v[116:119], v[124:127], v[80:95]
    ds_read_b128 v[116:119], v9 offset:41984
    v_cvt_pk_bf16_f32 v18, v20, v21
    v_cvt_pk_bf16_f32 v19, v22, v23
    v_exp_f32 v24, v24
    v_exp_f32 v25, v25
    v_exp_f32 v26, v26
    v_mfma_f32_32x32x16_bf16 v[96:111], v[128:131], v[16:19], v[96:111]
    v_exp_f32 v27, v27
    v_exp_f32 v28, v28
    v_exp_f32 v29, v29
    v_exp_f32 v30, v30
    v_exp_f32 v31, v31
    v_cvt_pk_bf16_f32 v24, v24, v25
    v_cvt_pk_bf16_f32 v25, v26, v27
    v_mfma_f32_32x32x4_2b_bf16 v[48:79], v[120:121], v[122:123], v[48:79]
    ds_read_b64 v[120:121], v10 offset:40960
    v_cvt_pk_bf16_f32 v26, v28, v29
    v_cvt_pk_bf16_f32 v27, v30, v31
    v_exp_f32 v32, v32
    v_exp_f32 v33, v33
    v_exp_f32 v34, v34
    v_exp_f32 v35, v35
    v_exp_f32 v36, v36
    v_exp_f32 v37, v37
    v_exp_f32 v38, v38
    v_mfma_f32_32x32x16_bf16 v[96:111], v[132:135], v[24:27], v[96:111]
    v_exp_f32 v39, v39
    v_cvt_pk_bf16_f32 v32, v32, v33
    v_cvt_pk_bf16_f32 v33, v34, v35
    v_cvt_pk_bf16_f32 v34, v36, v37
    v_exp_f32 v40, v40
    v_cvt_pk_bf16_f32 v35, v38, v39
    v_exp_f32 v41, v41
    v_exp_f32 v42, v42
    v_mfma_f32_32x32x16_bf16 v[96:111], v[136:139], v[32:35], v[96:111]
    v_exp_f32 v43, v43
    v_exp_f32 v44, v44
    v_exp_f32 v45, v45
    v_exp_f32 v46, v46
    v_exp_f32 v47, v47
    v_cvt_pk_bf16_f32 v40, v40, v41
    v_cvt_pk_bf16_f32 v41, v42, v43
    v_cvt_pk_bf16_f32 v42, v44, v45
    v_cvt_pk_bf16_f32 v43, v46, v47
    s_waitcnt lgkmcnt(0)
    v_mfma_f32_32x32x16_bf16 v[16:31], v[112:115], v[124:127], v[80:95]
    ds_read_b128 v[112:115], v9 offset:46080
    v_exp_f32 v48, v48
    v_exp_f32 v49, v49
    v_exp_f32 v50, v50
    v_exp_f32 v51, v51
    v_mfma_f32_32x32x16_bf16 v[96:111], v[140:143], v[40:43], v[96:111]
    s_mov_b64 exec, s[44:45]
    ds_read_b128 v[128:131], v11 offset:40960
    ds_read_b128 v[132:135], v11 offset:41600
    ds_read_b128 v[136:139], v11 offset:42240
    ds_read_b128 v[140:143], v11 offset:42880
    s_mov_b64 exec, -1
    v_exp_f32 v52, v52
    v_exp_f32 v53, v53
    v_exp_f32 v54, v54
    v_exp_f32 v55, v55
    v_cvt_pk_bf16_f32 v48, v48, v49
    v_cvt_pk_bf16_f32 v49, v50, v51
    v_mfma_f32_32x32x16_bf16 v[32:47], v[116:119], v[124:127], v[80:95]
    ds_read_b128 v[116:119], v9 offset:47104
    v_cvt_pk_bf16_f32 v50, v52, v53
    v_cvt_pk_bf16_f32 v51, v54, v55
    v_exp_f32 v56, v56
    v_exp_f32 v57, v57
    v_exp_f32 v58, v58
    v_mfma_f32_32x32x16_bf16 v[96:111], v[144:147], v[48:51], v[96:111]
    v_exp_f32 v59, v59
    v_exp_f32 v60, v60
    v_exp_f32 v61, v61
    v_exp_f32 v62, v62
    v_exp_f32 v63, v63
    v_cvt_pk_bf16_f32 v56, v56, v57
    v_cvt_pk_bf16_f32 v57, v58, v59
    v_mfma_f32_32x32x4_2b_bf16 v[16:47], v[120:121], v[122:123], v[16:47]
    ds_read_b64 v[120:121], v10 offset:46080
    v_cvt_pk_bf16_f32 v58, v60, v61
    v_cvt_pk_bf16_f32 v59, v62, v63
    v_exp_f32 v64, v64
    v_exp_f32 v65, v65
    v_exp_f32 v66, v66
    v_exp_f32 v67, v67
    v_exp_f32 v68, v68
    v_exp_f32 v69, v69
    v_exp_f32 v70, v70
    v_mfma_f32_32x32x16_bf16 v[96:111], v[148:151], v[56:59], v[96:111]
    v_exp_f32 v71, v71
    v_cvt_pk_bf16_f32 v64, v64, v65
    v_cvt_pk_bf16_f32 v65, v66, v67
    v_cvt_pk_bf16_f32 v66, v68, v69
    v_exp_f32 v72, v72
    v_cvt_pk_bf16_f32 v67, v70, v71
    v_exp_f32 v73, v73
    v_exp_f32 v74, v74
    v_mfma_f32_32x32x16_bf16 v[96:111], v[152:155], v[64:67], v[96:111]
    v_exp_f32 v75, v75
    v_exp_f32 v76, v76
    v_exp_f32 v77, v77
    v_exp_f32 v78, v78
    v_exp_f32 v79, v79
    v_cvt_pk_bf16_f32 v72, v72, v73
    v_cvt_pk_bf16_f32 v73, v74, v75
    v_cvt_pk_bf16_f32 v74, v76, v77
    v_cvt_pk_bf16_f32 v75, v78, v79
    v_add_u32 v9, 40960, v9
    v_add_u32 v10, 40960, v10
    v_add_u32 v11, 40960, v11
    s_sub_u32 s49, s49, 1
    s_cmp_lg_u32 s49, 0
    s_cbranch_scc1 A_LOOP
    v_mfma_f32_32x32x16_bf16 v[96:111], v[156:159], v[72:75], v[96:111]
    s_mul_i32 s40, s39, 40960
    s_add_u32 s40, s40, 16941056
    s_lshl_b32 s41, s36, 10
    s_add_u32 s41, s41, s40
    s_lshl_b32 s42, s36, 8
    s_add_u32 s42, s42, s40
    s_add_u32 s42, s42, 32768
    s_waitcnt lgkmcnt(0)
    s_nop 3
    v_cmp_gt_f32 vcc, 0x53800000, v108
    v_rcp_f32 v12, v108
    s_cmp_eq_u64 vcc, -1
    s_cbranch_scc0 A_FALL
A_FIN:
    s_nop 6
    v_mul_f32 v96, v12, v96
    v_mul_f32 v97, v12, v97
    v_mul_f32 v98, v12, v98
    v_mul_f32 v99, v12, v99
    v_mul_f32 v100, v12, v100
    v_mul_f32 v101, v12, v101
    v_mul_f32 v102, v12, v102
    v_mul_f32 v103, v12, v103
    v_mul_f32 v104, v12, v104
    v_mul_f32 v105, v12, v105
    v_mul_f32 v106, v12, v106
    v_mul_f32 v107, v12, v107
    v_cvt_pk_bf16_f32 v112, v96, v97
    v_cvt_pk_bf16_f32 v113, v98, v99
    v_cvt_pk_bf16_f32 v114, v100, v101
    v_cvt_pk_bf16_f32 v115, v102, v103
    v_cvt_pk_bf16_f32 v116, v104, v105
    v_cvt_pk_bf16_f32 v117, v106, v107
    v_min_u32 v112, -2, v112
    v_min_u32 v113, -2, v113
    v_min_u32 v114, -2, v114
    v_min_u32 v115, -2, v115
    v_min_u32 v116, -2, v116
    v_min_u32 v117, -2, v117
    s_mov_b32 s49, 200000
    s_mov_b32 s43, 0x100010
    s_mov_b64 exec, 0xffff
    s_waitcnt vmcnt(0)
A_WP:
    v_cmp_ne_u32 vcc, s43, v15
    s_sub_u32 s49, s49, 1
    s_cbranch_vccz A_WPX
    buffer_load_dword v15, v14, s[24:27], s48 offen sc1
    s_cmp_lg_u32 s49, 0
    s_waitcnt vmcnt(0)
    s_cbranch_scc1 A_WP
A_WPX:
    s_mov_b64 exec, -1
    buffer_store_dwordx4 v[112:115], v1, s[24:27], s41 offen sc1
    s_mov_b32 exec_hi, 0
    buffer_store_dwordx2 v[116:117], v5, s[24:27], s42 offen sc1
    s_mov_b32 exec_hi, -1
    s_bfe_u32 s50, s33, 0x10002
    s_mul_i32 s41, s50, 3072
    s_cmp_ge_u32 s35, 4
    s_cselect_b32 s41, 2048, s41
    s_mul_i32 s43, s34, 5120
    s_add_u32 s41, s41, s43
    s_add_u32 s41, s41, 16121856
    s_mul_i32 s43, s61, 40960
    s_add_u32 s55, s41, s43
    s_add_u32 s55, s55, 655360
    s_lshl_b32 s43, s43, 2
    s_add_u32 s41, s41, s43
    v_and_b32 v7, 32, v0
    v_lshl_add_u32 v7, v7, 4, v5
    v_lshlrev_b32 v3, 4, v3
    v_mad_u32_u24 v3, v4, s46, v3
    s_mul_i32 s43, s61, 20992
    s_add_u32 s43, s43, 23552
    v_add_u32 v3, s43, v3
    s_cmp_ge_u32 s35, 4
    s_cbranch_scc1 A_Y
    s_mul_i32 s43, s50, 384
    v_add_u32 v6, s43, v3
    s_sub_u32 s43, 384, s43
    v_add_u32 v3, s43, v3
    buffer_load_dwordx4 v[8:11], v1, s[24:27], s41 offen offset:0 sc1
    buffer_load_dwordx4 v[48:51], v1, s[24:27], s41 offen offset:1024 sc1
    s_add_u32 s41, s41, 20480
    buffer_load_dwordx4 v[12:15], v1, s[24:27], s41 offen offset:0 sc1
    buffer_load_dwordx4 v[52:55], v1, s[24:27], s41 offen offset:1024 sc1
    s_add_u32 s41, s41, 20480
    buffer_load_dwordx4 v[16:19], v1, s[24:27], s41 offen offset:0 sc1
    buffer_load_dwordx4 v[56:59], v1, s[24:27], s41 offen offset:1024 sc1
    s_add_u32 s41, s41, 20480
    buffer_load_dwordx4 v[20:23], v1, s[24:27], s41 offen offset:0 sc1
    buffer_load_dwordx4 v[60:63], v1, s[24:27], s41 offen offset:1024 sc1
    s_add_u32 s41, s41, 20480
    buffer_load_dwordx4 v[24:27], v1, s[24:27], s41 offen offset:0 sc1
    buffer_load_dwordx4 v[64:67], v1, s[24:27], s41 offen offset:1024 sc1
    s_add_u32 s41, s41, 20480
    buffer_load_dwordx4 v[28:31], v1, s[24:27], s41 offen offset:0 sc1
    buffer_load_dwordx4 v[68:71], v1, s[24:27], s41 offen offset:1024 sc1
    s_add_u32 s41, s41, 20480
    buffer_load_dwordx4 v[32:35], v1, s[24:27], s41 offen offset:0 sc1
    buffer_load_dwordx4 v[72:75], v1, s[24:27], s41 offen offset:1024 sc1
    s_add_u32 s41, s41, 20480
    buffer_load_dwordx4 v[36:39], v1, s[24:27], s41 offen offset:0 sc1
    buffer_load_dwordx4 v[76:79], v1, s[24:27], s41 offen offset:1024 sc1
    s_add_u32 s41, s41, 20480
    s_mov_b32 s41, s55
    buffer_load_dwordx4 v[40:43], v1, s[24:27], s41 offen offset:0 sc1
    buffer_load_dwordx4 v[80:83], v1, s[24:27], s41 offen offset:1024 sc1
    s_add_u32 s41, s41, 20480
    buffer_load_dwordx4 v[44:47], v1, s[24:27], s41 offen offset:0 sc1
    buffer_load_dwordx4 v[84:87], v1, s[24:27], s41 offen offset:1024 sc1
    s_add_u32 s41, s41, 20480
    s_lshl_b32 s50, s35, 6
    s_sub_u32 s50, s50, 128
    v_add_u32 v160, s50, v0
    s_movk_i32 s51, 3277
    v_mul_u32_u24 v161, s51, v160
    v_lshrrev_b32 v161, 16, v161
    v_lshlrev_b32 v164, 4, v161
    v_lshl_add_u32 v164, v160, 5, v164
    v_add_u32 v164, 2560, v164
    v_mul_u32_u24 v165, 1280, v161
    v_mul_u32_u24 v161, 20, v161
    v_sub_u32 v160, v160, v161
    v_and_b32 v161, 3, v160
    v_lshl_add_u32 v165, v161, 4, v165
    v_lshrrev_b32 v160, 2, v160
    s_bfe_u32 s50, s33, 0x10002
    s_mul_i32 s51, s50, 3
    s_mul_i32 s52, s50, 163840
    s_sub_u32 s53, 163648, s52
    v_cmp_eq_u32 vcc, 2, v160
    v_add_u32 v161, s51, v160
    v_mov_b32 v162, s52
    v_cndmask_b32 v161, v161, v160, vcc
    v_cmp_le_u32 vcc, 3, v160
    v_mov_b32 v163, s53
    v_lshl_add_u32 v165, v161, 6, v165
    v_cndmask_b32 v162, v162, v163, vcc
    s_andn2_b32 s54, s33, 4
    v_add_u32 v165, v165, v162
    s_mul_i32 s54, s54, 40960
    s_mul_i32 s51, s34, 320
    s_add_u32 s54, s54, s51
    buffer_load_dwordx4 v[160:163], v165, s[16:19], s54 offen
    s_andn2_b32 s43, s33, 4
    s_mul_i32 s40, s43, 40960
    s_add_u32 s40, s40, 16941056
    s_lshl_b32 s42, s61, 11
    s_add_u32 s42, s42, 32768
    s_add_u32 s42, s42, s40
    s_lshl_b32 s43, s61, 13
    s_add_u32 s40, s40, s43
    buffer_load_dwordx4 v[88:91], v1, s[24:27], s40 offen offset:0 sc1
    buffer_load_dwordx4 v[92:95], v1, s[24:27], s40 offen offset:1024 sc1
    buffer_load_dwordx4 v[96:99], v1, s[24:27], s40 offen offset:2048 sc1
    buffer_load_dwordx4 v[100:103], v1, s[24:27], s40 offen offset:3072 sc1
    buffer_load_dwordx2 v[120:121], v7, s[24:27], s42 offen offset:0 sc1
    buffer_load_dwordx2 v[122:123], v7, s[24:27], s42 offen offset:256 sc1
    buffer_load_dwordx4 v[104:107], v2, s[24:27], s40 offen offset:0 sc1
    buffer_load_dwordx4 v[108:111], v2, s[24:27], s40 offen offset:1024 sc1
    buffer_load_dwordx4 v[112:115], v2, s[24:27], s40 offen offset:2048 sc1
    buffer_load_dwordx4 v[116:119], v2, s[24:27], s40 offen offset:3072 sc1
    buffer_load_dwordx2 v[124:125], v7, s[24:27], s42 offen offset:1024 sc1
    buffer_load_dwordx2 v[126:127], v7, s[24:27], s42 offen offset:1280 sc1
    s_mov_b32 s49, 200000
    s_mov_b32 s47, 3
A_PE:
    s_waitcnt vmcnt(0)
    s_bitcmp1_b32 s47, 0
    s_cbranch_scc0 A_PEN0
    v_max_u32 v4, v88, v89
    v_max_u32 v5, v90, v91
    v_max3_u32 v4, v92, v93, v4
    v_max3_u32 v5, v94, v95, v5
    v_max3_u32 v4, v96, v97, v4
    v_max3_u32 v5, v98, v99, v5
    v_max3_u32 v4, v100, v101, v4
    v_max3_u32 v5, v102, v103, v5
    v_max3_u32 v4, v120, v121, v4
    v_max3_u32 v5, v122, v123, v5
    v_max_u32 v4, v4, v5
    v_cmp_eq_u32 vcc, -1, v4
    s_bitset0_b32 s47, 0
    s_cbranch_vccz A_PEN0
    s_bitset1_b32 s47, 0
    s_sleep 4
    buffer_load_dwordx4 v[88:91], v1, s[24:27], s40 offen offset:0 sc1
    buffer_load_dwordx4 v[92:95], v1, s[24:27], s40 offen offset:1024 sc1
    buffer_load_dwordx4 v[96:99], v1, s[24:27], s40 offen offset:2048 sc1
    buffer_load_dwordx4 v[100:103], v1, s[24:27], s40 offen offset:3072 sc1
    buffer_load_dwordx2 v[120:121], v7, s[24:27], s42 offen offset:0 sc1
    buffer_load_dwordx2 v[122:123], v7, s[24:27], s42 offen offset:256 sc1
A_PEN0:
    s_bitcmp1_b32 s47, 1
    s_cbranch_scc0 A_PEN1
    v_max_u32 v4, v104, v105
    v_max_u32 v5, v106, v107
    v_max3_u32 v4, v108, v109, v4
    v_max3_u32 v5, v110, v111, v5
    v_max3_u32 v4, v112, v113, v4
    v_max3_u32 v5, v114, v115, v5
    v_max3_u32 v4, v116, v117, v4
    v_max3_u32 v5, v118, v119, v5
    v_max3_u32 v4, v124, v125, v4
    v_max3_u32 v5, v126, v127, v5
    v_max_u32 v4, v4, v5
    v_cmp_eq_u32 vcc, -1, v4
    s_bitset0_b32 s47, 1
    s_cbranch_vccz A_PEN1
    s_bitset1_b32 s47, 1
    s_sleep 4
    buffer_load_dwordx4 v[104:107], v2, s[24:27], s40 offen offset:0 sc1
    buffer_load_dwordx4 v[108:111], v2, s[24:27], s40 offen offset:1024 sc1
    buffer_load_dwordx4 v[112:115], v2, s[24:27], s40 offen offset:2048 sc1
    buffer_load_dwordx4 v[116:119], v2, s[24:27], s40 offen offset:3072 sc1
    buffer_load_dwordx2 v[124:125], v7, s[24:27], s42 offen offset:1024 sc1
    buffer_load_dwordx2 v[126:127], v7, s[24:27], s42 offen offset:1280 sc1
A_PEN1:
    s_sub_u32 s49, s49, 1
    s_min_u32 s43, s49, s47
    s_cmp_lg_u32 s43, 0
    s_cbranch_scc1 A_PE
    s_waitcnt vmcnt(0)
    v_mfma_f32_32x32x16_bf16 v[128:143], v[8:11], v[88:91], 0
    v_mfma_f32_32x32x16_bf16 v[144:159], v[48:51], v[88:91], 0
    v_mfma_f32_32x32x16_bf16 v[128:143], v[12:15], v[92:95], v[128:143]
    v_mfma_f32_32x32x16_bf16 v[144:159], v[52:55], v[92:95], v[144:159]
    v_mfma_f32_32x32x16_bf16 v[128:143], v[16:19], v[96:99], v[128:143]
    v_mfma_f32_32x32x16_bf16 v[144:159], v[56:59], v[96:99], v[144:159]
    v_mfma_f32_32x32x16_bf16 v[128:143], v[20:23], v[100:103], v[128:143]
    v_mfma_f32_32x32x16_bf16 v[144:159], v[60:63], v[100:103], v[144:159]
    v_mfma_f32_32x32x16_bf16 v[128:143], v[24:27], v[104:107], v[128:143]
    v_mfma_f32_32x32x16_bf16 v[144:159], v[64:67], v[104:107], v[144:159]
    v_mfma_f32_32x32x16_bf16 v[128:143], v[28:31], v[108:111], v[128:143]
    v_mfma_f32_32x32x16_bf16 v[144:159], v[68:71], v[108:111], v[144:159]
    v_mfma_f32_32x32x16_bf16 v[128:143], v[32:35], v[112:115], v[128:143]
    v_mfma_f32_32x32x16_bf16 v[144:159], v[72:75], v[112:115], v[144:159]
    v_mfma_f32_32x32x16_bf16 v[128:143], v[36:39], v[116:119], v[128:143]
    v_mfma_f32_32x32x16_bf16 v[144:159], v[76:79], v[116:119], v[144:159]
    v_mfma_f32_32x32x16_bf16 v[128:143], v[40:43], v[120:123], v[128:143]
    v_mfma_f32_32x32x16_bf16 v[144:159], v[80:83], v[120:123], v[144:159]
    v_mfma_f32_32x32x16_bf16 v[128:143], v[44:47], v[124:127], v[128:143]
    v_mfma_f32_32x32x16_bf16 v[144:159], v[84:87], v[124:127], v[144:159]
    s_or_b32 s43, s33, 4
    s_mul_i32 s40, s43, 40960
    s_add_u32 s40, s40, 16941056
    s_lshl_b32 s42, s61, 11
    s_add_u32 s42, s42, 32768
    s_add_u32 s42, s42, s40
    s_lshl_b32 s43, s61, 13
    s_add_u32 s40, s40, s43
    s_barrier
    buffer_load_dwordx4 v[88:91], v1, s[24:27], s40 offen offset:0 sc1
    buffer_load_dwordx4 v[92:95], v1, s[24:27], s40 offen offset:1024 sc1
    buffer_load_dwordx4 v[96:99], v1, s[24:27], s40 offen offset:2048 sc1
    buffer_load_dwordx4 v[100:103], v1, s[24:27], s40 offen offset:3072 sc1
    buffer_load_dwordx2 v[120:121], v7, s[24:27], s42 offen offset:0 sc1
    buffer_load_dwordx2 v[122:123], v7, s[24:27], s42 offen offset:256 sc1
    buffer_load_dwordx4 v[104:107], v2, s[24:27], s40 offen offset:0 sc1
    buffer_load_dwordx4 v[108:111], v2, s[24:27], s40 offen offset:1024 sc1
    buffer_load_dwordx4 v[112:115], v2, s[24:27], s40 offen offset:2048 sc1
    buffer_load_dwordx4 v[116:119], v2, s[24:27], s40 offen offset:3072 sc1
    buffer_load_dwordx2 v[124:125], v7, s[24:27], s42 offen offset:1024 sc1
    buffer_load_dwordx2 v[126:127], v7, s[24:27], s42 offen offset:1280 sc1
    ds_write_b128 v6, v[128:131] offset:0
    ds_write_b128 v6, v[132:135] offset:32
    ds_write_b128 v6, v[136:139] offset:64
    ds_write_b128 v6, v[140:143] offset:96
    ds_write_b128 v6, v[144:147] offset:128
    ds_write_b128 v6, v[148:151] offset:160
    ds_write_b128 v6, v[152:155] offset:192
    ds_write_b128 v6, v[156:159] offset:224
    s_mov_b32 s49, 200000
    s_mov_b32 s47, 3
A_PL:
    s_waitcnt vmcnt(0)
    s_bitcmp1_b32 s47, 0
    s_cbranch_scc0 A_PLN0
    v_max_u32 v4, v88, v89
    v_max_u32 v5, v90, v91
    v_max3_u32 v4, v92, v93, v4
    v_max3_u32 v5, v94, v95, v5
    v_max3_u32 v4, v96, v97, v4
    v_max3_u32 v5, v98, v99, v5
    v_max3_u32 v4, v100, v101, v4
    v_max3_u32 v5, v102, v103, v5
    v_max3_u32 v4, v120, v121, v4
    v_max3_u32 v5, v122, v123, v5
    v_max_u32 v4, v4, v5
    v_cmp_eq_u32 vcc, -1, v4
    s_bitset0_b32 s47, 0
    s_cbranch_vccz A_PLN0
    s_bitset1_b32 s47, 0
    s_sleep 4
    buffer_load_dwordx4 v[88:91], v1, s[24:27], s40 offen offset:0 sc1
    buffer_load_dwordx4 v[92:95], v1, s[24:27], s40 offen offset:1024 sc1
    buffer_load_dwordx4 v[96:99], v1, s[24:27], s40 offen offset:2048 sc1
    buffer_load_dwordx4 v[100:103], v1, s[24:27], s40 offen offset:3072 sc1
    buffer_load_dwordx2 v[120:121], v7, s[24:27], s42 offen offset:0 sc1
    buffer_load_dwordx2 v[122:123], v7, s[24:27], s42 offen offset:256 sc1
A_PLN0:
    s_bitcmp1_b32 s47, 1
    s_cbranch_scc0 A_PLN1
    v_max_u32 v4, v104, v105
    v_max_u32 v5, v106, v107
    v_max3_u32 v4, v108, v109, v4
    v_max3_u32 v5, v110, v111, v5
    v_max3_u32 v4, v112, v113, v4
    v_max3_u32 v5, v114, v115, v5
    v_max3_u32 v4, v116, v117, v4
    v_max3_u32 v5, v118, v119, v5
    v_max3_u32 v4, v124, v125, v4
    v_max3_u32 v5, v126, v127, v5
    v_max_u32 v4, v4, v5
    v_cmp_eq_u32 vcc, -1, v4
    s_bitset0_b32 s47, 1
    s_cbranch_vccz A_PLN1
    s_bitset1_b32 s47, 1
    s_sleep 4
    buffer_load_dwordx4 v[104:107], v2, s[24:27], s40 offen offset:0 sc1
    buffer_load_dwordx4 v[108:111], v2, s[24:27], s40 offen offset:1024 sc1
    buffer_load_dwordx4 v[112:115], v2, s[24:27], s40 offen offset:2048 sc1
    buffer_load_dwordx4 v[116:119], v2, s[24:27], s40 offen offset:3072 sc1
    buffer_load_dwordx2 v[124:125], v7, s[24:27], s42 offen offset:1024 sc1
    buffer_load_dwordx2 v[126:127], v7, s[24:27], s42 offen offset:1280 sc1
A_PLN1:
    s_sub_u32 s49, s49, 1
    s_min_u32 s43, s49, s47
    s_cmp_lg_u32 s43, 0
    s_cbranch_scc1 A_PL
    s_waitcnt vmcnt(0)
    s_waitcnt lgkmcnt(0)
    v_mfma_f32_32x32x16_bf16 v[128:143], v[8:11], v[88:91], 0
    v_mfma_f32_32x32x16_bf16 v[144:159], v[48:51], v[88:91], 0
    v_mfma_f32_32x32x16_bf16 v[128:143], v[12:15], v[92:95], v[128:143]
    v_mfma_f32_32x32x16_bf16 v[144:159], v[52:55], v[92:95], v[144:159]
    v_mfma_f32_32x32x16_bf16 v[128:143], v[16:19], v[96:99], v[128:143]
    v_mfma_f32_32x32x16_bf16 v[144:159], v[56:59], v[96:99], v[144:159]
    v_mfma_f32_32x32x16_bf16 v[128:143], v[20:23], v[100:103], v[128:143]
    v_mfma_f32_32x32x16_bf16 v[144:159], v[60:63], v[100:103], v[144:159]
    v_mfma_f32_32x32x16_bf16 v[128:143], v[24:27], v[104:107], v[128:143]
    v_mfma_f32_32x32x16_bf16 v[144:159], v[64:67], v[104:107], v[144:159]
    v_mfma_f32_32x32x16_bf16 v[128:143], v[28:31], v[108:111], v[128:143]
    v_mfma_f32_32x32x16_bf16 v[144:159], v[68:71], v[108:111], v[144:159]
    v_mfma_f32_32x32x16_bf16 v[128:143], v[32:35], v[112:115], v[128:143]
    v_mfma_f32_32x32x16_bf16 v[144:159], v[72:75], v[112:115], v[144:159]
    v_mfma_f32_32x32x16_bf16 v[128:143], v[36:39], v[116:119], v[128:143]
    v_mfma_f32_32x32x16_bf16 v[144:159], v[76:79], v[116:119], v[144:159]
    v_mfma_f32_32x32x16_bf16 v[128:143], v[40:43], v[120:123], v[128:143]
    v_mfma_f32_32x32x16_bf16 v[144:159], v[80:83], v[120:123], v[144:159]
    v_mfma_f32_32x32x16_bf16 v[128:143], v[44:47], v[124:127], v[128:143]
    v_mfma_f32_32x32x16_bf16 v[144:159], v[84:87], v[124:127], v[144:159]
    s_nop 10
    ds_write_b128 v3, v[128:131] offset:0
    ds_write_b128 v3, v[132:135] offset:32
    ds_write_b128 v3, v[136:139] offset:64
    ds_write_b128 v3, v[140:143] offset:96
    ds_write_b128 v3, v[144:147] offset:128
    ds_write_b128 v3, v[148:151] offset:160
    ds_write_b128 v3, v[152:155] offset:192
    ds_write_b128 v3, v[156:159] offset:224
    s_branch M_FINAL
A_Y:
    buffer_load_dwordx4 v[8:11], v1, s[24:27], s41 offen offset:0 sc1
    s_add_u32 s41, s41, 20480
    buffer_load_dwordx4 v[12:15], v1, s[24:27], s41 offen offset:0 sc1
    s_add_u32 s41, s41, 20480
    buffer_load_dwordx4 v[16:19], v1, s[24:27], s41 offen offset:0 sc1
    s_add_u32 s41, s41, 20480
    buffer_load_dwordx4 v[20:23], v1, s[24:27], s41 offen offset:0 sc1
    s_add_u32 s41, s41, 20480
    buffer_load_dwordx4 v[24:27], v1, s[24:27], s41 offen offset:0 sc1
    s_add_u32 s41, s41, 20480
    buffer_load_dwordx4 v[28:31], v1, s[24:27], s41 offen offset:0 sc1
    s_add_u32 s41, s41, 20480
    buffer_load_dwordx4 v[32:35], v1, s[24:27], s41 offen offset:0 sc1
    s_add_u32 s41, s41, 20480
    buffer_load_dwordx4 v[36:39], v1, s[24:27], s41 offen offset:0 sc1
    s_add_u32 s41, s41, 20480
    s_mov_b32 s41, s55
    buffer_load_dwordx4 v[40:43], v1, s[24:27], s41 offen offset:0 sc1
    s_add_u32 s41, s41, 20480
    buffer_load_dwordx4 v[44:47], v1, s[24:27], s41 offen offset:0 sc1
    s_add_u32 s41, s41, 20480
    s_lshl_b32 s50, s35, 6
    s_sub_u32 s50, s50, 128
    v_add_u32 v160, s50, v0
    s_movk_i32 s51, 3277
    v_mul_u32_u24 v161, s51, v160
    v_lshrrev_b32 v161, 16, v161
    v_lshlrev_b32 v164, 4, v161
    v_lshl_add_u32 v164, v160, 5, v164
    v_add_u32 v164, 2560, v164
    v_mul_u32_u24 v165, 1280, v161
    v_mul_u32_u24 v161, 20, v161
    v_sub_u32 v160, v160, v161
    v_and_b32 v161, 3, v160
    v_lshl_add_u32 v165, v161, 4, v165
    v_lshrrev_b32 v160, 2, v160
    s_bfe_u32 s50, s33, 0x10002
    s_mul_i32 s51, s50, 3
    s_mul_i32 s52, s50, 163840
    s_sub_u32 s53, 163648, s52
    v_cmp_eq_u32 vcc, 2, v160
    v_add_u32 v161, s51, v160
    v_mov_b32 v162, s52
    v_cndmask_b32 v161, v161, v160, vcc
    v_cmp_le_u32 vcc, 3, v160
    v_mov_b32 v163, s53
    v_lshl_add_u32 v165, v161, 6, v165
    v_cndmask_b32 v162, v162, v163, vcc
    s_andn2_b32 s54, s33, 4
    v_add_u32 v165, v165, v162
    s_mul_i32 s54, s54, 40960
    s_mul_i32 s51, s34, 320
    s_add_u32 s54, s54, s51
    buffer_load_dwordx4 v[160:163], v165, s[16:19], s54 offen
    s_mul_i32 s40, s33, 40960
    s_add_u32 s40, s40, 16941056
    s_lshl_b32 s42, s61, 11
    s_add_u32 s42, s42, 32768
    s_add_u32 s42, s42, s40
    s_lshl_b32 s43, s61, 13
    s_add_u32 s40, s40, s43
    s_barrier
    buffer_load_dwordx4 v[88:91], v1, s[24:27], s40 offen offset:0 sc1
    buffer_load_dwordx4 v[92:95], v1, s[24:27], s40 offen offset:1024 sc1
    buffer_load_dwordx4 v[96:99], v1, s[24:27], s40 offen offset:2048 sc1
    buffer_load_dwordx4 v[100:103], v1, s[24:27], s40 offen offset:3072 sc1
    buffer_load_dwordx2 v[120:121], v7, s[24:27], s42 offen offset:0 sc1
    buffer_load_dwordx2 v[122:123], v7, s[24:27], s42 offen offset:256 sc1
    buffer_load_dwordx4 v[104:107], v2, s[24:27], s40 offen offset:0 sc1
    buffer_load_dwordx4 v[108:111], v2, s[24:27], s40 offen offset:1024 sc1
    buffer_load_dwordx4 v[112:115], v2, s[24:27], s40 offen offset:2048 sc1
    buffer_load_dwordx4 v[116:119], v2, s[24:27], s40 offen offset:3072 sc1
    buffer_load_dwordx2 v[124:125], v7, s[24:27], s42 offen offset:1024 sc1
    buffer_load_dwordx2 v[126:127], v7, s[24:27], s42 offen offset:1280 sc1
    s_mov_b32 s49, 200000
    s_mov_b32 s47, 3
A_PY:
    s_waitcnt vmcnt(0)
    s_bitcmp1_b32 s47, 0
    s_cbranch_scc0 A_PYN0
    v_max_u32 v4, v88, v89
    v_max_u32 v5, v90, v91
    v_max3_u32 v4, v92, v93, v4
    v_max3_u32 v5, v94, v95, v5
    v_max3_u32 v4, v96, v97, v4
    v_max3_u32 v5, v98, v99, v5
    v_max3_u32 v4, v100, v101, v4
    v_max3_u32 v5, v102, v103, v5
    v_max3_u32 v4, v120, v121, v4
    v_max3_u32 v5, v122, v123, v5
    v_max_u32 v4, v4, v5
    v_cmp_eq_u32 vcc, -1, v4
    s_bitset0_b32 s47, 0
    s_cbranch_vccz A_PYN0
    s_bitset1_b32 s47, 0
    s_sleep 4
    buffer_load_dwordx4 v[88:91], v1, s[24:27], s40 offen offset:0 sc1
    buffer_load_dwordx4 v[92:95], v1, s[24:27], s40 offen offset:1024 sc1
    buffer_load_dwordx4 v[96:99], v1, s[24:27], s40 offen offset:2048 sc1
    buffer_load_dwordx4 v[100:103], v1, s[24:27], s40 offen offset:3072 sc1
    buffer_load_dwordx2 v[120:121], v7, s[24:27], s42 offen offset:0 sc1
    buffer_load_dwordx2 v[122:123], v7, s[24:27], s42 offen offset:256 sc1
A_PYN0:
    s_bitcmp1_b32 s47, 1
    s_cbranch_scc0 A_PYN1
    v_max_u32 v4, v104, v105
    v_max_u32 v5, v106, v107
    v_max3_u32 v4, v108, v109, v4
    v_max3_u32 v5, v110, v111, v5
    v_max3_u32 v4, v112, v113, v4
    v_max3_u32 v5, v114, v115, v5
    v_max3_u32 v4, v116, v117, v4
    v_max3_u32 v5, v118, v119, v5
    v_max3_u32 v4, v124, v125, v4
    v_max3_u32 v5, v126, v127, v5
    v_max_u32 v4, v4, v5
    v_cmp_eq_u32 vcc, -1, v4
    s_bitset0_b32 s47, 1
    s_cbranch_vccz A_PYN1
    s_bitset1_b32 s47, 1
    s_sleep 4
    buffer_load_dwordx4 v[104:107], v2, s[24:27], s40 offen offset:0 sc1
    buffer_load_dwordx4 v[108:111], v2, s[24:27], s40 offen offset:1024 sc1
    buffer_load_dwordx4 v[112:115], v2, s[24:27], s40 offen offset:2048 sc1
    buffer_load_dwordx4 v[116:119], v2, s[24:27], s40 offen offset:3072 sc1
    buffer_load_dwordx2 v[124:125], v7, s[24:27], s42 offen offset:1024 sc1
    buffer_load_dwordx2 v[126:127], v7, s[24:27], s42 offen offset:1280 sc1
A_PYN1:
    s_sub_u32 s49, s49, 1
    s_min_u32 s43, s49, s47
    s_cmp_lg_u32 s43, 0
    s_cbranch_scc1 A_PY
    s_waitcnt vmcnt(0)
    v_mfma_f32_32x32x16_bf16 v[128:143], v[8:11], v[88:91], 0
    v_mfma_f32_32x32x16_bf16 v[128:143], v[12:15], v[92:95], v[128:143]
    v_mfma_f32_32x32x16_bf16 v[128:143], v[16:19], v[96:99], v[128:143]
    v_mfma_f32_32x32x16_bf16 v[128:143], v[20:23], v[100:103], v[128:143]
    v_mfma_f32_32x32x16_bf16 v[128:143], v[24:27], v[104:107], v[128:143]
    v_mfma_f32_32x32x16_bf16 v[128:143], v[28:31], v[108:111], v[128:143]
    v_mfma_f32_32x32x16_bf16 v[128:143], v[32:35], v[112:115], v[128:143]
    v_mfma_f32_32x32x16_bf16 v[128:143], v[36:39], v[116:119], v[128:143]
    v_mfma_f32_32x32x16_bf16 v[128:143], v[40:43], v[120:123], v[128:143]
    v_mfma_f32_32x32x16_bf16 v[128:143], v[44:47], v[124:127], v[128:143]
    s_nop 11
    ds_write_b128 v3, v[128:131] offset:256
    ds_write_b128 v3, v[132:135] offset:288
    ds_write_b128 v3, v[136:139] offset:320
    ds_write_b128 v3, v[140:143] offset:352
    s_branch M_FINAL
A_B2:
    s_barrier
    s_setprio 3
    s_branch A_B2R
A_PR:
    s_setprio 2
    s_cmp_eq_u32 s49, 2
    s_cbranch_scc1 A_PRR
    s_setprio 1
    s_cmp_lg_u32 s49, 1
    s_cbranch_scc1 A_PRR
    s_mov_b64 exec, 0xffff
    buffer_load_dword v15, v14, s[24:27], s48 offen sc1
    s_mov_b64 exec, -1
    s_branch A_PRR
A_FALL:
    v_mov_b32 v12, 0xff800000
    s_mov_b32 s49, 32
    s_mov_b32 s47, s38
A_MAXL:
    buffer_load_dwordx4 v[112:115], v1, s[24:27], s47 offen sc1
    buffer_load_dwordx4 v[116:119], v1, s[24:27], s47 offen offset:1024 sc1
    buffer_load_dwordx2 v[120:121], v7, s[24:27], s47 offen sc1
    s_add_u32 s47, s47, 5120
    s_waitcnt vmcnt(0)
    v_mfma_f32_32x32x16_bf16 v[16:31], v[112:115], v[124:127], 0
    v_mfma_f32_32x32x16_bf16 v[32:47], v[116:119], v[124:127], 0
    s_nop 9
    v_mfma_f32_32x32x4_2b_bf16 v[16:47], v[120:121], v[122:123], v[16:47]
    s_nop 15
    s_nop 3
    v_max3_f32 v12, v16, v17, v12
    v_max3_f32 v12, v18, v19, v12
    v_max3_f32 v12, v20, v21, v12
    v_max3_f32 v12, v22, v23, v12
    v_max3_f32 v12, v24, v25, v12
    v_max3_f32 v12, v26, v27, v12
    v_max3_f32 v12, v28, v29, v12
    v_max3_f32 v12, v30, v31, v12
    v_max3_f32 v12, v32, v33, v12
    v_max3_f32 v12, v34, v35, v12
    v_max3_f32 v12, v36, v37, v12
    v_max3_f32 v12, v38, v39, v12
    v_max3_f32 v12, v40, v41, v12
    v_max3_f32 v12, v42, v43, v12
    v_max3_f32 v12, v44, v45, v12
    v_max3_f32 v12, v46, v47, v12
    s_sub_u32 s49, s49, 1
    s_cmp_lg_u32 s49, 0
    s_cbranch_scc1 A_MAXL
    v_mov_b32 v13, v12
    s_nop 1
    v_permlane32_swap_b32 v12, v13
    v_max_f32 v12, v12, v13
    v_sub_f32 v80, 0, v12
    v_mov_b32 v81, v80
    v_mov_b32 v82, v80
    v_mov_b32 v83, v80
    v_mov_b32 v84, v80
    v_mov_b32 v85, v80
    v_mov_b32 v86, v80
    v_mov_b32 v87, v80
    v_mov_b32 v88, v80
    v_mov_b32 v89, v80
    v_mov_b32 v90, v80
    v_mov_b32 v91, v80
    v_mov_b32 v92, v80
    v_mov_b32 v93, v80
    v_mov_b32 v94, v80
    v_mov_b32 v95, v80
    v_mov_b32 v96, 0
    v_mov_b32 v97, 0
    v_mov_b32 v98, 0
    v_mov_b32 v99, 0
    v_mov_b32 v100, 0
    v_mov_b32 v101, 0
    v_mov_b32 v102, 0
    v_mov_b32 v103, 0
    v_mov_b32 v104, 0
    v_mov_b32 v105, 0
    v_mov_b32 v106, 0
    v_mov_b32 v107, 0
    v_mov_b32 v108, 0
    v_mov_b32 v109, 0
    v_mov_b32 v110, 0
    v_mov_b32 v111, 0
    s_mov_b32 s49, 32
    s_mov_b32 s47, s38
A_SLOW:
    buffer_load_dwordx4 v[112:115], v1, s[24:27], s47 offen sc1
    buffer_load_dwordx4 v[116:119], v1, s[24:27], s47 offen offset:1024 sc1
    buffer_load_dwordx2 v[120:121], v7, s[24:27], s47 offen sc1
    s_mov_b64 exec, s[44:45]
    buffer_load_dwordx4 v[128:131], v8, s[24:27], s47 offen offset:0 sc1
    buffer_load_dwordx4 v[132:135], v8, s[24:27], s47 offen offset:640 sc1
    buffer_load_dwordx4 v[136:139], v8, s[24:27], s47 offen offset:1280 sc1
    buffer_load_dwordx4 v[140:143], v8, s[24:27], s47 offen offset:1920 sc1
    s_mov_b64 exec, -1
    s_add_u32 s47, s47, 5120
    s_waitcnt vmcnt(0)
    v_mfma_f32_32x32x16_bf16 v[16:31], v[112:115], v[124:127], v[80:95]
    v_mfma_f32_32x32x16_bf16 v[32:47], v[116:119], v[124:127], v[80:95]
    s_nop 9
    v_mfma_f32_32x32x4_2b_bf16 v[16:47], v[120:121], v[122:123], v[16:47]
    s_nop 15
    s_nop 3
    v_exp_f32 v16, v16
    v_exp_f32 v17, v17
    v_exp_f32 v18, v18
    v_exp_f32 v19, v19
    v_exp_f32 v20, v20
    v_exp_f32 v21, v21
    v_exp_f32 v22, v22
    v_exp_f32 v23, v23
    v_exp_f32 v24, v24
    v_exp_f32 v25, v25
    v_exp_f32 v26, v26
    v_exp_f32 v27, v27
    v_exp_f32 v28, v28
    v_exp_f32 v29, v29
    v_exp_f32 v30, v30
    v_exp_f32 v31, v31
    v_exp_f32 v32, v32
    v_exp_f32 v33, v33
    v_exp_f32 v34, v34
    v_exp_f32 v35, v35
    v_exp_f32 v36, v36
    v_exp_f32 v37, v37
    v_exp_f32 v38, v38
    v_exp_f32 v39, v39
    v_exp_f32 v40, v40
    v_exp_f32 v41, v41
    v_exp_f32 v42, v42
    v_exp_f32 v43, v43
    v_exp_f32 v44, v44
    v_exp_f32 v45, v45
    v_exp_f32 v46, v46
    v_exp_f32 v47, v47
    v_cvt_pk_bf16_f32 v16, v16, v17
    v_cvt_pk_bf16_f32 v17, v18, v19
    v_cvt_pk_bf16_f32 v18, v20, v21
    v_cvt_pk_bf16_f32 v19, v22, v23
    v_cvt_pk_bf16_f32 v24, v24, v25
    v_cvt_pk_bf16_f32 v25, v26, v27
    v_cvt_pk_bf16_f32 v26, v28, v29
    v_cvt_pk_bf16_f32 v27, v30, v31
    v_cvt_pk_bf16_f32 v32, v32, v33
    v_cvt_pk_bf16_f32 v33, v34, v35
    v_cvt_pk_bf16_f32 v34, v36, v37
    v_cvt_pk_bf16_f32 v35, v38, v39
    v_cvt_pk_bf16_f32 v40, v40, v41
    v_cvt_pk_bf16_f32 v41, v42, v43
    v_cvt_pk_bf16_f32 v42, v44, v45
    v_cvt_pk_bf16_f32 v43, v46, v47
    v_mfma_f32_32x32x16_bf16 v[96:111], v[128:131], v[16:19], v[96:111]
    v_mfma_f32_32x32x16_bf16 v[96:111], v[132:135], v[24:27], v[96:111]
    v_mfma_f32_32x32x16_bf16 v[96:111], v[136:139], v[32:35], v[96:111]
    v_mfma_f32_32x32x16_bf16 v[96:111], v[140:143], v[40:43], v[96:111]
    s_sub_u32 s49, s49, 1
    s_cmp_lg_u32 s49, 0
    s_cbranch_scc1 A_SLOW
    s_nop 8
    v_rcp_f32 v12, v108
    s_branch A_FIN
M_COMP:
    s_setprio 3
    s_waitcnt lgkmcnt(0)
    s_mov_b32 s16, s4
    s_mov_b32 s17, s5
    s_mov_b32 s18, 2621440
    s_mov_b32 s19, 0x20000
    s_mov_b32 s20, s64
    s_mov_b32 s21, s65
    s_mov_b32 s22, 2621440
    s_mov_b32 s23, 0x20000
    s_mov_b32 s24, s10
    s_mov_b32 s25, s11
    s_mov_b32 s26, 19955712
    s_mov_b32 s27, 0x20000
    s_lshl_b32 s58, s2, 2
    s_add_u32 s58, s58, s61
    s_mov_b32 s28, s14
    s_mov_b32 s29, s15
    s_mov_b32 s30, 1966080
    s_mov_b32 s31, 0x20000
    s_mov_b32 s68, s8
    s_mov_b32 s69, s9
    s_mov_b32 s70, 819200
    s_mov_b32 s71, 0x20000
    v_lshrrev_b32 v3, 2, v0
    v_and_b32 v2, 3, v0
    v_and_b32 v6, 3, v3
    v_bfe_u32 v7, v3, 2, 1
    v_lshl_add_u32 v7, v7, 3, v6
    v_lshrrev_b32 v8, 3, v3
    v_lshl_add_u32 v7, v8, 2, v7
    v_mul_u32_u24 v7, 1280, v7
    v_lshl_add_u32 v149, v2, 4, v7
    v_lshrrev_b32 v8, 2, v3
    v_mul_u32_u24 v8, 20, v8
    v_add3_u32 v8, v8, v6, 16
    v_mul_u32_u24 v8, 1280, v8
    v_lshl_add_u32 v8, v2, 4, v8
    s_min_u32 s59, s58, 959
    s_mul_i32 s50, s59, 6554
    s_lshr_b32 s50, s50, 16
    s_mul_i32 s51, s50, 10
    s_sub_u32 s51, s59, s51
    s_mul_i32 s50, s50, 20480
    s_lshl_b32 s51, s51, 7
    s_add_u32 s72, s50, s51
    s_min_u32 s59, s58, 799
    s_mul_i32 s51, s59, 3277
    s_lshr_b32 s51, s51, 16
    s_mul_i32 s52, s51, 20
    s_sub_u32 s52, s59, s52
    s_mul_i32 s53, s51, 25600
    s_sub_u32 s40, s51, 32
    s_mul_i32 s40, s40, 102400
    s_cmp_ge_u32 s51, 32
    s_cselect_b32 s53, s40, s53
    s_cselect_b64 vcc, -1, 0
    v_cndmask_b32 v150, v149, v8, vcc
    s_lshl_b32 s52, s52, 6
    s_add_u32 s73, s53, s52
    s_lshl_b32 s74, s61, 10
    s_add_u32 s74, s74, 40960
    v_lshrrev_b32 v9, 5, v0
    v_lshlrev_b32 v9, 9, v9
    v_bfe_u32 v3, v0, 2, 2
    v_lshl_add_u32 v9, v3, 6, v9
    v_and_b32 v3, 16, v0
    v_lshl_add_u32 v9, v3, 1, v9
    v_lshl_add_u32 v9, v2, 3, v9
    v_add_u32 v151, s74, v9
    v_and_b32 v3, 31, v0
    v_lshrrev_b32 v14, 5, v0
    v_and_b32 v15, 7, v0
    v_xor_b32 v6, v15, v14
    v_lshlrev_b32 v6, 4, v6
    v_lshl_add_u32 v6, v3, 7, v6
    s_lshl_b32 s40, s61, 12
    s_add_u32 s40, s40, 2560
    v_add_u32 v152, s40, v6
    v_lshrrev_b32 v6, 3, v0
    v_xor_b32 v7, v15, v6
    v_lshlrev_b32 v7, 4, v7
    v_lshl_add_u32 v7, v6, 7, v7
    s_lshl_b32 s40, s61, 10
    s_add_u32 s40, s40, 2560
    v_add_u32 v153, s40, v7
    v_mul_u32_u24 v7, 656, v6
    v_lshl_add_u32 v7, v15, 4, v7
    s_mul_i32 s40, s61, 5248
    s_add_u32 s40, s40, 2560
    v_add_u32 v154, s40, v7
    v_mul_u32_u24 v3, 656, v3
    v_lshl_add_u32 v3, v14, 4, v3
    s_mul_i32 s40, s61, 20992
    s_add_u32 s40, s40, 24064
    v_add_u32 v155, s40, v3
    v_and_b32 v1, 31, v0
    v_lshrrev_b32 v2, 5, v0
    v_bfe_u32 v3, v0, 1, 3
    v_xor_b32 v3, v3, v2
    v_lshlrev_b32 v3, 4, v3
    v_lshl_add_u32 v3, v1, 7, v3
    s_lshl_b32 s40, s61, 12
    s_add_u32 s40, s40, 65536
    v_add_u32 v140, s40, v3
    v_xor_b32 v141, 32, v140
    v_xor_b32 v142, 64, v140
    v_xor_b32 v143, 96, v140
    v_bfe_u32 v3, v0, 2, 2
    v_lshl_add_u32 v4, v2, 3, v3
    v_and_b32 v5, 16, v0
    v_lshlrev_b32 v5, 1, v5
    v_and_b32 v6, 3, v0
    v_lshl_add_u32 v5, v6, 3, v5
    v_add_u32 v5, 98304, v5
    v_lshl_add_u32 v144, v4, 8, v5
    v_lshl_add_u32 v144, v3, 6, v144
    v_xor_b32 v145, 64, v144
    v_xor_b32 v146, 128, v144
    v_xor_b32 v147, 192, v144
    v_mul_u32_u24 v148, 192, v4
    v_add3_u32 v148, v148, v5, 0
    v_add_u32 v148, 32768, v148
    v_mov_b32 v16, 0
    v_mov_b32 v17, 0
    v_mov_b32 v18, 0
    v_mov_b32 v19, 0
    v_mov_b32 v20, 0
    v_mov_b32 v21, 0
    v_mov_b32 v22, 0
    v_mov_b32 v23, 0
    v_mov_b32 v24, 0
    v_mov_b32 v25, 0
    v_mov_b32 v26, 0
    v_mov_b32 v27, 0
    v_mov_b32 v28, 0
    v_mov_b32 v29, 0
    v_mov_b32 v30, 0
    v_mov_b32 v31, 0
    v_mov_b32 v32, 0
    v_mov_b32 v33, 0
    v_mov_b32 v34, 0
    v_mov_b32 v35, 0
    v_mov_b32 v36, 0
    v_mov_b32 v37, 0
    v_mov_b32 v38, 0
    v_mov_b32 v39, 0
    v_mov_b32 v40, 0
    v_mov_b32 v41, 0
    v_mov_b32 v42, 0
    v_mov_b32 v43, 0
    v_mov_b32 v44, 0
    v_mov_b32 v45, 0
    v_mov_b32 v46, 0
    v_mov_b32 v47, 0
    v_mov_b32 v48, 0
    v_mov_b32 v49, 0
    v_mov_b32 v50, 0
    v_mov_b32 v51, 0
    v_mov_b32 v52, 0
    v_mov_b32 v53, 0
    v_mov_b32 v54, 0
    v_mov_b32 v55, 0
    v_mov_b32 v56, 0
    v_mov_b32 v57, 0
    v_mov_b32 v58, 0
    v_mov_b32 v59, 0
    v_mov_b32 v60, 0
    v_mov_b32 v61, 0
    v_mov_b32 v62, 0
    v_mov_b32 v63, 0
    v_mov_b32 v64, 0
    v_mov_b32 v65, 0
    v_mov_b32 v66, 0
    v_mov_b32 v67, 0
    v_mov_b32 v68, 0
    v_mov_b32 v69, 0
    v_mov_b32 v70, 0
    v_mov_b32 v71, 0
    v_mov_b32 v72, 0
    v_mov_b32 v73, 0
    v_mov_b32 v74, 0
    v_mov_b32 v75, 0
    v_mov_b32 v76, 0
    v_mov_b32 v77, 0
    v_mov_b32 v78, 0
    v_mov_b32 v79, 0
    s_min_u32 s42, s63, 14
    s_mul_i32 s41, s42, 13
    s_lshr_b32 s41, s41, 6
    s_mul_i32 s40, s41, 5
    s_sub_u32 s42, s42, s40
    s_lshl_b32 s48, s62, 2
    s_add_u32 s48, s48, s61
    s_mov_b32 s47, 4
    s_mov_b32 s46, 2
    s_mov_b32 s59, 0xffff0000
    s_mov_b32 s39, 0x8000
    s_lshr_b32 s33, s3, 1
    s_lshl_b32 s33, s33, 4
    s_and_b32 s40, s32, 15
    s_add_u32 s33, s33, s40
    s_and_b32 s34, s3, 1
    s_lshl_b32 s34, s34, 1
    s_lshr_b32 s40, s32, 4
    s_add_u32 s34, s34, s40
    s_lshl_b32 s36, s3, 2
    s_and_b32 s40, s32, 3
    s_add_u32 s36, s36, s40
    s_lshr_b32 s37, s32, 2
    s_mul_i32 s38, s36, 163840
    s_add_u32 s38, s38, 2621440
    s_mul_i32 s60, s37, 20480
    v_lshlrev_b32 v9, 3, v1
    v_add_u32 v9, 143360, v9
    s_lshl_b32 s43, s61, 7
    s_add_u32 s43, s43, 144384
    v_lshlrev_b32 v10, 4, v0
    s_mov_b32 s56, -1
    s_mov_b32 s57, 0
    s_lshl_b32 s40, s42, 7
    v_add_u32 v3, s40, v1
    v_mul_u32_u24 v11, 320, v2
    s_mov_b32 s50, 52429
    s_mov_b32 s51, 163520
    v_mul_u32_u24 v8, s50, v3
    v_lshrrev_b32 v8, 20, v8
    v_mul_u32_u24 v8, s51, v8
    v_lshl_add_u32 v8, v3, 4, v8
    v_add_u32 v4, v8, v11
    v_add_u32 v3, 32, v3
    v_mul_u32_u24 v8, s50, v3
    v_lshrrev_b32 v8, 20, v8
    v_mul_u32_u24 v8, s51, v8
    v_lshl_add_u32 v8, v3, 4, v8
    v_add_u32 v5, v8, v11
    v_add_u32 v3, 32, v3
    v_mul_u32_u24 v8, s50, v3
    v_lshrrev_b32 v8, 20, v8
    v_mul_u32_u24 v8, s51, v8
    v_lshl_add_u32 v8, v3, 4, v8
    v_add_u32 v6, v8, v11
    v_add_u32 v3, 32, v3
    v_mul_u32_u24 v8, s50, v3
    v_lshrrev_b32 v8, 20, v8
    v_mul_u32_u24 v8, s51, v8
    v_lshl_add_u32 v8, v3, 4, v8
    v_add_u32 v7, v8, v11
    v_add_u32 v3, 32, v3
    v_lshl_add_u32 v8, v1, 2, s43
    v_lshl_add_u32 v3, v2, 4, s43
    s_mul_i32 s50, s48, 1280
    s_add_u32 s51, s50, 1024
    s_lshr_b32 s52, s48, 1
    s_mul_i32 s52, s52, 5120
    s_add_u32 s52, s52, 2621440
    s_and_b32 s53, s48, 1
    s_lshl_b32 s54, s53, 10
    s_add_u32 s54, s54, s52
    s_lshl_b32 s55, s53, 8
    s_add_u32 s55, s55, s52
    s_add_u32 s55, s55, 2048
    s_mul_i32 s53, s53, 1280
    s_add_u32 s52, s52, s53
    s_add_u32 s52, s52, 2560
    s_cmp_eq_u32 s63, 15
    s_cselect_b32 s52, 19955712, s52
    s_mov_b32 s49, 163840
    s_cmp_eq_u32 s41, 0
    s_cselect_b32 s49, 81920, s49
    s_cselect_b32 s50, s50, s54
    s_cselect_b32 s51, s51, s55
    s_cselect_b32 s53, 0x3ea52b5c, 1.0
    v_mul_lo_u32 v11, v2, s49
    v_lshl_add_u32 v11, v1, 3, v11
    s_waitcnt vmcnt(0)
    s_barrier
    ds_read_b128 v[80:83], v140 offset:0
    ds_read_b64_tr_b16 v[88:89], v144 offset:0
    ds_read_b64_tr_b16 v[90:91], v144 offset:1024
    ds_read_b64_tr_b16 v[92:93], v145 offset:0
    ds_read_b64_tr_b16 v[94:95], v145 offset:1024
    ds_read_b64_tr_b16 v[96:97], v146 offset:0
    ds_read_b64_tr_b16 v[98:99], v146 offset:1024
    ds_read_b64_tr_b16 v[100:101], v147 offset:0
    ds_read_b64_tr_b16 v[102:103], v147 offset:1024
    ds_read_b128 v[84:87], v141 offset:0
    ds_read_b64_tr_b16 v[104:105], v144 offset:4096
    ds_read_b64_tr_b16 v[106:107], v144 offset:5120
    ds_read_b64_tr_b16 v[108:109], v145 offset:4096
    ds_read_b64_tr_b16 v[110:111], v145 offset:5120
    ds_read_b64_tr_b16 v[112:113], v146 offset:4096
    ds_read_b64_tr_b16 v[114:115], v146 offset:5120
    ds_read_b64_tr_b16 v[116:117], v147 offset:4096
    ds_read_b64_tr_b16 v[118:119], v147 offset:5120
    s_cmp_eq_u32 s41, 2
    s_cbranch_scc1 C1_L1
C1_L0:
    s_waitcnt lgkmcnt(9)
    v_mfma_f32_32x32x16_bf16 v[16:31], v[88:91], v[80:83], v[16:31]
    ds_read_b64_tr_b16 v[88:89], v144 offset:8192
    ds_read_b64_tr_b16 v[90:91], v144 offset:9216
    v_mfma_f32_32x32x16_bf16 v[32:47], v[92:95], v[80:83], v[32:47]
    ds_read_b64_tr_b16 v[92:93], v145 offset:8192
    ds_read_b64_tr_b16 v[94:95], v145 offset:9216
    v_mfma_f32_32x32x16_bf16 v[48:63], v[96:99], v[80:83], v[48:63]
    ds_read_b64_tr_b16 v[96:97], v146 offset:8192
    ds_read_b64_tr_b16 v[98:99], v146 offset:9216
    v_mfma_f32_32x32x16_bf16 v[64:79], v[100:103], v[80:83], v[64:79]
    ds_read_b64_tr_b16 v[100:101], v147 offset:8192
    ds_read_b64_tr_b16 v[102:103], v147 offset:9216
    ds_read_b128 v[80:83], v142 offset:0
    s_waitcnt lgkmcnt(9)
    v_mfma_f32_32x32x16_bf16 v[16:31], v[104:107], v[84:87], v[16:31]
    ds_read_b64_tr_b16 v[104:105], v144 offset:12288
    ds_read_b64_tr_b16 v[106:107], v144 offset:13312
    v_mfma_f32_32x32x16_bf16 v[32:47], v[108:111], v[84:87], v[32:47]
    ds_read_b64_tr_b16 v[108:109], v145 offset:12288
    ds_read_b64_tr_b16 v[110:111], v145 offset:13312
    v_mfma_f32_32x32x16_bf16 v[48:63], v[112:115], v[84:87], v[48:63]
    ds_read_b64_tr_b16 v[112:113], v146 offset:12288
    ds_read_b64_tr_b16 v[114:115], v146 offset:13312
    v_mfma_f32_32x32x16_bf16 v[64:79], v[116:119], v[84:87], v[64:79]
    ds_read_b64_tr_b16 v[116:117], v147 offset:12288
    ds_read_b64_tr_b16 v[118:119], v147 offset:13312
    ds_read_b128 v[84:87], v143 offset:0
    s_waitcnt lgkmcnt(9)
    v_mfma_f32_32x32x16_bf16 v[16:31], v[88:91], v[80:83], v[16:31]
    v_mfma_f32_32x32x16_bf16 v[32:47], v[92:95], v[80:83], v[32:47]
    s_waitcnt lgkmcnt(0)
    s_barrier
    v_mfma_f32_32x32x16_bf16 v[48:63], v[96:99], v[80:83], v[48:63]
    ds_read_b64_tr_b16 v[88:89], v144 offset:16384
    ds_read_b64_tr_b16 v[90:91], v144 offset:17408
    ds_read_b64_tr_b16 v[92:93], v145 offset:16384
    ds_read_b64_tr_b16 v[94:95], v145 offset:17408
    v_mfma_f32_32x32x16_bf16 v[64:79], v[100:103], v[80:83], v[64:79]
    ds_read_b64_tr_b16 v[96:97], v146 offset:16384
    ds_read_b64_tr_b16 v[98:99], v146 offset:17408
    ds_read_b64_tr_b16 v[100:101], v147 offset:16384
    ds_read_b64_tr_b16 v[102:103], v147 offset:17408
    ds_read_b128 v[80:83], v140 offset:16384
    s_waitcnt lgkmcnt(9)
    v_mfma_f32_32x32x16_bf16 v[16:31], v[104:107], v[84:87], v[16:31]
    ds_read_b64_tr_b16 v[104:105], v144 offset:20480
    ds_read_b64_tr_b16 v[106:107], v144 offset:21504
    v_mfma_f32_32x32x16_bf16 v[32:47], v[108:111], v[84:87], v[32:47]
    ds_read_b64_tr_b16 v[108:109], v145 offset:20480
    ds_read_b64_tr_b16 v[110:111], v145 offset:21504
    v_mfma_f32_32x32x16_bf16 v[48:63], v[112:115], v[84:87], v[48:63]
    ds_read_b64_tr_b16 v[112:113], v146 offset:20480
    ds_read_b64_tr_b16 v[114:115], v146 offset:21504
    v_mfma_f32_32x32x16_bf16 v[64:79], v[116:119], v[84:87], v[64:79]
    ds_read_b64_tr_b16 v[116:117], v147 offset:20480
    ds_read_b64_tr_b16 v[118:119], v147 offset:21504
    ds_read_b128 v[84:87], v141 offset:16384
    s_waitcnt lgkmcnt(9)
    v_mfma_f32_32x32x16_bf16 v[16:31], v[88:91], v[80:83], v[16:31]
    s_add_u32 s46, s46, 1
    s_cmp_eq_u32 s46, 3
    s_cselect_b32 s46, 0, s46
    s_cselect_b32 s45, s59, s39
    ds_read_b64_tr_b16 v[88:89], v144 offset:24576
    ds_read_b64_tr_b16 v[90:91], v144 offset:25600
    v_mfma_f32_32x32x16_bf16 v[32:47], v[92:95], v[80:83], v[32:47]
    ds_read_b64_tr_b16 v[92:93], v145 offset:24576
    ds_read_b64_tr_b16 v[94:95], v145 offset:25600
    v_mfma_f32_32x32x16_bf16 v[48:63], v[96:99], v[80:83], v[48:63]
    ds_read_b64_tr_b16 v[96:97], v146 offset:24576
    ds_read_b64_tr_b16 v[98:99], v146 offset:25600
    v_mfma_f32_32x32x16_bf16 v[64:79], v[100:103], v[80:83], v[64:79]
    ds_read_b64_tr_b16 v[100:101], v147 offset:24576
    ds_read_b64_tr_b16 v[102:103], v147 offset:25600
    ds_read_b128 v[80:83], v142 offset:16384
    s_waitcnt lgkmcnt(9)
    v_mfma_f32_32x32x16_bf16 v[16:31], v[104:107], v[84:87], v[16:31]
    ds_read_b64_tr_b16 v[104:105], v144 offset:28672
    ds_read_b64_tr_b16 v[106:107], v144 offset:29696
    v_mfma_f32_32x32x16_bf16 v[32:47], v[108:111], v[84:87], v[32:47]
    ds_read_b64_tr_b16 v[108:109], v145 offset:28672
    ds_read_b64_tr_b16 v[110:111], v145 offset:29696
    v_mfma_f32_32x32x16_bf16 v[48:63], v[112:115], v[84:87], v[48:63]
    ds_read_b64_tr_b16 v[112:113], v146 offset:28672
    ds_read_b64_tr_b16 v[114:115], v146 offset:29696
    v_mfma_f32_32x32x16_bf16 v[64:79], v[116:119], v[84:87], v[64:79]
    ds_read_b64_tr_b16 v[116:117], v147 offset:28672
    ds_read_b64_tr_b16 v[118:119], v147 offset:29696
    ds_read_b128 v[84:87], v143 offset:16384
    s_waitcnt lgkmcnt(9)
    v_mfma_f32_32x32x16_bf16 v[16:31], v[88:91], v[80:83], v[16:31]
    v_mfma_f32_32x32x16_bf16 v[32:47], v[92:95], v[80:83], v[32:47]
    s_waitcnt lgkmcnt(0)
    s_barrier
    v_xor_b32 v144, 0x38000, v144
    v_xor_b32 v145, 0x38000, v145
    v_xor_b32 v146, 0x38000, v146
    v_xor_b32 v147, 0x38000, v147
    v_mfma_f32_32x32x16_bf16 v[48:63], v[96:99], v[80:83], v[48:63]
    ds_read_b64_tr_b16 v[88:89], v144 offset:0
    ds_read_b64_tr_b16 v[90:91], v144 offset:1024
    ds_read_b64_tr_b16 v[92:93], v145 offset:0
    ds_read_b64_tr_b16 v[94:95], v145 offset:1024
    v_mfma_f32_32x32x16_bf16 v[64:79], v[100:103], v[80:83], v[64:79]
    v_add_u32 v140, s45, v140
    ds_read_b64_tr_b16 v[96:97], v146 offset:0
    ds_read_b64_tr_b16 v[98:99], v146 offset:1024
    ds_read_b64_tr_b16 v[100:101], v147 offset:0
    ds_read_b64_tr_b16 v[102:103], v147 offset:1024
    ds_read_b128 v[80:83], v140 offset:0
    v_add_u32 v141, s45, v141
    v_add_u32 v142, s45, v142
    v_add_u32 v143, s45, v143
    s_waitcnt lgkmcnt(9)
    v_mfma_f32_32x32x16_bf16 v[16:31], v[104:107], v[84:87], v[16:31]
    ds_read_b64_tr_b16 v[104:105], v144 offset:4096
    ds_read_b64_tr_b16 v[106:107], v144 offset:5120
    v_mfma_f32_32x32x16_bf16 v[32:47], v[108:111], v[84:87], v[32:47]
    ds_read_b64_tr_b16 v[108:109], v145 offset:4096
    ds_read_b64_tr_b16 v[110:111], v145 offset:5120
    v_mfma_f32_32x32x16_bf16 v[48:63], v[112:115], v[84:87], v[48:63]
    ds_read_b64_tr_b16 v[112:113], v146 offset:4096
    ds_read_b64_tr_b16 v[114:115], v146 offset:5120
    v_mfma_f32_32x32x16_bf16 v[64:79], v[116:119], v[84:87], v[64:79]
    ds_read_b64_tr_b16 v[116:117], v147 offset:4096
    ds_read_b64_tr_b16 v[118:119], v147 offset:5120
    ds_read_b128 v[84:87], v141 offset:0
    s_sub_u32 s47, s47, 1
    s_cmp_lg_u32 s47, 0
    s_cbranch_scc1 C1_L0
    s_branch C1_EPI
C1_L1:
    s_waitcnt lgkmcnt(9)
    v_mfma_f32_32x32x16_bf16 v[16:31], v[80:83], v[88:91], v[16:31]
    ds_read_b64_tr_b16 v[88:89], v144 offset:8192
    ds_read_b64_tr_b16 v[90:91], v144 offset:9216
    v_mfma_f32_32x32x16_bf16 v[32:47], v[80:83], v[92:95], v[32:47]
    ds_read_b64_tr_b16 v[92:93], v145 offset:8192
    ds_read_b64_tr_b16 v[94:95], v145 offset:9216
    v_mfma_f32_32x32x16_bf16 v[48:63], v[80:83], v[96:99], v[48:63]
    ds_read_b64_tr_b16 v[96:97], v146 offset:8192
    ds_read_b64_tr_b16 v[98:99], v146 offset:9216
    v_mfma_f32_32x32x16_bf16 v[64:79], v[80:83], v[100:103], v[64:79]
    ds_read_b64_tr_b16 v[100:101], v147 offset:8192
    ds_read_b64_tr_b16 v[102:103], v147 offset:9216
    ds_read_b128 v[80:83], v142 offset:0
    s_waitcnt lgkmcnt(9)
    v_mfma_f32_32x32x16_bf16 v[16:31], v[84:87], v[104:107], v[16:31]
    ds_read_b64_tr_b16 v[104:105], v144 offset:12288
    ds_read_b64_tr_b16 v[106:107], v144 offset:13312
    v_mfma_f32_32x32x16_bf16 v[32:47], v[84:87], v[108:111], v[32:47]
    ds_read_b64_tr_b16 v[108:109], v145 offset:12288
    ds_read_b64_tr_b16 v[110:111], v145 offset:13312
    v_mfma_f32_32x32x16_bf16 v[48:63], v[84:87], v[112:115], v[48:63]
    ds_read_b64_tr_b16 v[112:113], v146 offset:12288
    ds_read_b64_tr_b16 v[114:115], v146 offset:13312
    v_mfma_f32_32x32x16_bf16 v[64:79], v[84:87], v[116:119], v[64:79]
    ds_read_b64_tr_b16 v[116:117], v147 offset:12288
    ds_read_b64_tr_b16 v[118:119], v147 offset:13312
    ds_read_b128 v[84:87], v143 offset:0
    s_waitcnt lgkmcnt(9)
    v_mfma_f32_32x32x16_bf16 v[16:31], v[80:83], v[88:91], v[16:31]
    v_mfma_f32_32x32x16_bf16 v[32:47], v[80:83], v[92:95], v[32:47]
    s_waitcnt lgkmcnt(0)
    s_barrier
    v_mfma_f32_32x32x16_bf16 v[48:63], v[80:83], v[96:99], v[48:63]
    ds_read_b64_tr_b16 v[88:89], v144 offset:16384
    ds_read_b64_tr_b16 v[90:91], v144 offset:17408
    ds_read_b64_tr_b16 v[92:93], v145 offset:16384
    ds_read_b64_tr_b16 v[94:95], v145 offset:17408
    v_mfma_f32_32x32x16_bf16 v[64:79], v[80:83], v[100:103], v[64:79]
    ds_read_b64_tr_b16 v[96:97], v146 offset:16384
    ds_read_b64_tr_b16 v[98:99], v146 offset:17408
    ds_read_b64_tr_b16 v[100:101], v147 offset:16384
    ds_read_b64_tr_b16 v[102:103], v147 offset:17408
    ds_read_b128 v[80:83], v140 offset:16384
    s_waitcnt lgkmcnt(9)
    v_mfma_f32_32x32x16_bf16 v[16:31], v[84:87], v[104:107], v[16:31]
    ds_read_b64_tr_b16 v[104:105], v144 offset:20480
    ds_read_b64_tr_b16 v[106:107], v144 offset:21504
    v_mfma_f32_32x32x16_bf16 v[32:47], v[84:87], v[108:111], v[32:47]
    ds_read_b64_tr_b16 v[108:109], v145 offset:20480
    ds_read_b64_tr_b16 v[110:111], v145 offset:21504
    v_mfma_f32_32x32x16_bf16 v[48:63], v[84:87], v[112:115], v[48:63]
    ds_read_b64_tr_b16 v[112:113], v146 offset:20480
    ds_read_b64_tr_b16 v[114:115], v146 offset:21504
    v_mfma_f32_32x32x16_bf16 v[64:79], v[84:87], v[116:119], v[64:79]
    ds_read_b64_tr_b16 v[116:117], v147 offset:20480
    ds_read_b64_tr_b16 v[118:119], v147 offset:21504
    ds_read_b128 v[84:87], v141 offset:16384
    s_waitcnt lgkmcnt(9)
    v_mfma_f32_32x32x16_bf16 v[16:31], v[80:83], v[88:91], v[16:31]
    s_add_u32 s46, s46, 1
    s_cmp_eq_u32 s46, 3
    s_cselect_b32 s46, 0, s46
    s_cselect_b32 s45, s59, s39
    ds_read_b64_tr_b16 v[88:89], v144 offset:24576
    ds_read_b64_tr_b16 v[90:91], v144 offset:25600
    v_mfma_f32_32x32x16_bf16 v[32:47], v[80:83], v[92:95], v[32:47]
    ds_read_b64_tr_b16 v[92:93], v145 offset:24576
    ds_read_b64_tr_b16 v[94:95], v145 offset:25600
    v_mfma_f32_32x32x16_bf16 v[48:63], v[80:83], v[96:99], v[48:63]
    ds_read_b64_tr_b16 v[96:97], v146 offset:24576
    ds_read_b64_tr_b16 v[98:99], v146 offset:25600
    v_mfma_f32_32x32x16_bf16 v[64:79], v[80:83], v[100:103], v[64:79]
    ds_read_b64_tr_b16 v[100:101], v147 offset:24576
    ds_read_b64_tr_b16 v[102:103], v147 offset:25600
    ds_read_b128 v[80:83], v142 offset:16384
    s_waitcnt lgkmcnt(9)
    v_mfma_f32_32x32x16_bf16 v[16:31], v[84:87], v[104:107], v[16:31]
    ds_read_b64_tr_b16 v[104:105], v144 offset:28672
    ds_read_b64_tr_b16 v[106:107], v144 offset:29696
    v_mfma_f32_32x32x16_bf16 v[32:47], v[84:87], v[108:111], v[32:47]
    ds_read_b64_tr_b16 v[108:109], v145 offset:28672
    ds_read_b64_tr_b16 v[110:111], v145 offset:29696
    v_mfma_f32_32x32x16_bf16 v[48:63], v[84:87], v[112:115], v[48:63]
    ds_read_b64_tr_b16 v[112:113], v146 offset:28672
    ds_read_b64_tr_b16 v[114:115], v146 offset:29696
    v_mfma_f32_32x32x16_bf16 v[64:79], v[84:87], v[116:119], v[64:79]
    ds_read_b64_tr_b16 v[116:117], v147 offset:28672
    ds_read_b64_tr_b16 v[118:119], v147 offset:29696
    ds_read_b128 v[84:87], v143 offset:16384
    s_waitcnt lgkmcnt(9)
    v_mfma_f32_32x32x16_bf16 v[16:31], v[80:83], v[88:91], v[16:31]
    v_mfma_f32_32x32x16_bf16 v[32:47], v[80:83], v[92:95], v[32:47]
    s_waitcnt lgkmcnt(0)
    s_barrier
    v_xor_b32 v144, 0x38000, v144
    v_xor_b32 v145, 0x38000, v145
    v_xor_b32 v146, 0x38000, v146
    v_xor_b32 v147, 0x38000, v147
    v_mfma_f32_32x32x16_bf16 v[48:63], v[80:83], v[96:99], v[48:63]
    ds_read_b64_tr_b16 v[88:89], v144 offset:0
    ds_read_b64_tr_b16 v[90:91], v144 offset:1024
    ds_read_b64_tr_b16 v[92:93], v145 offset:0
    ds_read_b64_tr_b16 v[94:95], v145 offset:1024
    v_mfma_f32_32x32x16_bf16 v[64:79], v[80:83], v[100:103], v[64:79]
    v_add_u32 v140, s45, v140
    ds_read_b64_tr_b16 v[96:97], v146 offset:0
    ds_read_b64_tr_b16 v[98:99], v146 offset:1024
    ds_read_b64_tr_b16 v[100:101], v147 offset:0
    ds_read_b64_tr_b16 v[102:103], v147 offset:1024
    ds_read_b128 v[80:83], v140 offset:0
    v_add_u32 v141, s45, v141
    v_add_u32 v142, s45, v142
    v_add_u32 v143, s45, v143
    s_waitcnt lgkmcnt(9)
    v_mfma_f32_32x32x16_bf16 v[16:31], v[84:87], v[104:107], v[16:31]
    ds_read_b64_tr_b16 v[104:105], v144 offset:4096
    ds_read_b64_tr_b16 v[106:107], v144 offset:5120
    v_mfma_f32_32x32x16_bf16 v[32:47], v[84:87], v[108:111], v[32:47]
    ds_read_b64_tr_b16 v[108:109], v145 offset:4096
    ds_read_b64_tr_b16 v[110:111], v145 offset:5120
    v_mfma_f32_32x32x16_bf16 v[48:63], v[84:87], v[112:115], v[48:63]
    ds_read_b64_tr_b16 v[112:113], v146 offset:4096
    ds_read_b64_tr_b16 v[114:115], v146 offset:5120
    v_mfma_f32_32x32x16_bf16 v[64:79], v[84:87], v[116:119], v[64:79]
    ds_read_b64_tr_b16 v[116:117], v147 offset:4096
    ds_read_b64_tr_b16 v[118:119], v147 offset:5120
    ds_read_b128 v[84:87], v141 offset:0
    s_sub_u32 s47, s47, 1
    s_cmp_lg_u32 s47, 0
    s_cbranch_scc1 C1_L1
    s_branch C1_T5
C1_EPI:
    s_cmp_eq_u32 s42, 1
    s_cbranch_scc1 C1_T1
    s_cmp_eq_u32 s42, 2
    s_cbranch_scc1 C1_T2
    s_cmp_eq_u32 s42, 3
    s_cbranch_scc1 C1_T3
    s_cmp_eq_u32 s42, 4
    s_cbranch_scc1 C1_T4
C1_T0:
    s_waitcnt lgkmcnt(9)
    v_mfma_f32_32x32x16_bf16 v[16:31], v[88:91], v[80:83], v[16:31]
    s_barrier
    ds_read_b64_tr_b16 v[88:89], v144 offset:8192
    ds_read_b64_tr_b16 v[90:91], v144 offset:9216
    ds_read_b128 v[120:123], v142 offset:0
    ds_read_b128 v[124:127], v143 offset:0
    v_mfma_f32_32x32x16_bf16 v[32:47], v[92:95], v[80:83], v[32:47]
    ds_read_b64_tr_b16 v[92:93], v144 offset:12288
    ds_read_b64_tr_b16 v[94:95], v144 offset:13312
    ds_read_b128 v[128:131], v140 offset:16384
    ds_read_b128 v[132:135], v141 offset:16384
    v_mfma_f32_32x32x16_bf16 v[48:63], v[96:99], v[80:83], v[48:63]
    ds_read_b64_tr_b16 v[96:97], v144 offset:16384
    ds_read_b64_tr_b16 v[98:99], v144 offset:17408
    ds_read_b128 v[136:139], v142 offset:16384
    ds_read_b128 v[156:159], v143 offset:16384
    v_mfma_f32_32x32x16_bf16 v[64:79], v[100:103], v[80:83], v[64:79]
    ds_read_b64_tr_b16 v[100:101], v144 offset:20480
    ds_read_b64_tr_b16 v[102:103], v144 offset:21504
    s_waitcnt lgkmcnt(14)
    v_mfma_f32_32x32x16_bf16 v[16:31], v[104:107], v[84:87], v[16:31]
    ds_read_b64_tr_b16 v[104:105], v144 offset:24576
    ds_read_b64_tr_b16 v[106:107], v144 offset:25600
    v_mfma_f32_32x32x16_bf16 v[32:47], v[108:111], v[84:87], v[32:47]
    ds_read_b64_tr_b16 v[108:109], v144 offset:28672
    ds_read_b64_tr_b16 v[110:111], v144 offset:29696
    v_mfma_f32_32x32x16_bf16 v[48:63], v[112:115], v[84:87], v[48:63]
    s_add_u32 s46, s46, 1
    s_cmp_eq_u32 s46, 3
    s_cselect_b32 s46, 0, s46
    s_cselect_b32 s45, s59, s39
    v_add_u32 v140, s45, v140
    v_add_u32 v141, s45, v141
    v_mfma_f32_32x32x16_bf16 v[64:79], v[116:119], v[84:87], v[64:79]
    v_add_u32 v142, s45, v142
    v_add_u32 v143, s45, v143
    s_waitcnt lgkmcnt(14)
    v_mfma_f32_32x32x16_bf16 v[16:31], v[88:91], v[120:123], v[16:31]
    ds_read_b64_tr_b16 v[88:89], v145 offset:8192
    ds_read_b64_tr_b16 v[90:91], v145 offset:9216
    s_waitcnt lgkmcnt(14)
    v_mfma_f32_32x32x16_bf16 v[16:31], v[92:95], v[124:127], v[16:31]
    ds_read_b64_tr_b16 v[92:93], v145 offset:12288
    ds_read_b64_tr_b16 v[94:95], v145 offset:13312
    s_waitcnt lgkmcnt(12)
    v_mfma_f32_32x32x16_bf16 v[16:31], v[96:99], v[128:131], v[16:31]
    ds_read_b64_tr_b16 v[96:97], v145 offset:16384
    ds_read_b64_tr_b16 v[98:99], v145 offset:17408
    s_waitcnt lgkmcnt(10)
    v_mfma_f32_32x32x16_bf16 v[16:31], v[100:103], v[132:135], v[16:31]
    ds_read_b64_tr_b16 v[100:101], v145 offset:20480
    ds_read_b64_tr_b16 v[102:103], v145 offset:21504
    s_waitcnt lgkmcnt(10)
    v_mfma_f32_32x32x16_bf16 v[16:31], v[104:107], v[136:139], v[16:31]
    ds_read_b64_tr_b16 v[104:105], v145 offset:24576
    ds_read_b64_tr_b16 v[106:107], v145 offset:25600
    s_waitcnt lgkmcnt(10)
    v_mfma_f32_32x32x16_bf16 v[16:31], v[108:111], v[156:159], v[16:31]
    ds_read_b64_tr_b16 v[108:109], v145 offset:28672
    ds_read_b64_tr_b16 v[110:111], v145 offset:29696
    s_barrier
    ds_read_b32 v14, v8 offset:512
    ds_read_b32 v12, v8
    ds_read_b64 v[160:161], v9 offset:0
    ds_read_b64 v[162:163], v9 offset:256
    ds_read_b64 v[164:165], v9 offset:512
    ds_read_b64 v[166:167], v9 offset:768
    s_waitcnt lgkmcnt(14)
    v_mfma_f32_32x32x16_bf16 v[32:47], v[88:91], v[120:123], v[32:47]
    ds_read_b64_tr_b16 v[88:89], v146 offset:8192
    ds_read_b64_tr_b16 v[90:91], v146 offset:9216
    s_waitcnt lgkmcnt(14)
    v_mfma_f32_32x32x16_bf16 v[32:47], v[92:95], v[124:127], v[32:47]
    s_waitcnt lgkmcnt(2)
    v_cndmask_b32 v14, 0, v14, s[56:57]
    v_mul_f32 v13, s53, v12
    v_and_b32 v15, 0xffff, v14
    ds_read_b64_tr_b16 v[92:93], v146 offset:12288
    ds_read_b64_tr_b16 v[94:95], v146 offset:13312
    v_mfma_f32_32x32x8bf16_1k v[16:31], v[160:161], v[14:15], v[16:31]
    v_mfma_f32_32x32x16_bf16 v[32:47], v[96:99], v[128:131], v[32:47]
    ds_read_b64_tr_b16 v[96:97], v146 offset:16384
    ds_read_b64_tr_b16 v[98:99], v146 offset:17408
    v_mfma_f32_32x32x8bf16_1k v[32:47], v[162:163], v[14:15], v[32:47]
    v_mfma_f32_32x32x16_bf16 v[32:47], v[100:103], v[132:135], v[32:47]
    ds_read_b64_tr_b16 v[100:101], v146 offset:20480
    ds_read_b64_tr_b16 v[102:103], v146 offset:21504
    v_mfma_f32_32x32x16_bf16 v[32:47], v[104:107], v[136:139], v[32:47]
    ds_read_b64_tr_b16 v[104:105], v146 offset:24576
    ds_read_b64_tr_b16 v[106:107], v146 offset:25600
    s_nop 1
    v_mul_f32 v16, v13, v16
    v_mul_f32 v17, v13, v17
    v_mul_f32 v18, v13, v18
    v_mul_f32 v19, v13, v19
    v_mul_f32 v20, v13, v20
    v_mul_f32 v21, v13, v21
    v_mfma_f32_32x32x16_bf16 v[32:47], v[108:111], v[156:159], v[32:47]
    ds_read_b64_tr_b16 v[108:109], v146 offset:28672
    ds_read_b64_tr_b16 v[110:111], v146 offset:29696
    v_mul_f32 v22, v13, v22
    v_mul_f32 v23, v13, v23
    v_cvt_pk_bf16_f32 v16, v16, v17
    v_cvt_pk_bf16_f32 v17, v18, v19
    v_cvt_pk_bf16_f32 v18, v20, v21
    v_cvt_pk_bf16_f32 v19, v22, v23
    v_mfma_f32_32x32x8bf16_1k v[48:63], v[164:165], v[14:15], v[48:63]
    s_waitcnt lgkmcnt(10)
    v_mfma_f32_32x32x16_bf16 v[48:63], v[88:91], v[120:123], v[48:63]
    ds_read_b64_tr_b16 v[88:89], v147 offset:8192
    ds_read_b64_tr_b16 v[90:91], v147 offset:9216
    s_mul_i32 s40, s49, 0
    s_add_u32 s40, s40, s50
    buffer_store_dwordx4 v[16:19], v10, s[24:27], s40 offen sc1
    v_mul_f32 v24, v13, v24
    v_mul_f32 v25, v13, v25
    v_mul_f32 v26, v13, v26
    v_mul_f32 v27, v13, v27
    v_cvt_pk_bf16_f32 v24, v24, v25
    s_waitcnt lgkmcnt(10)
    v_mfma_f32_32x32x16_bf16 v[48:63], v[92:95], v[124:127], v[48:63]
    ds_read_b64_tr_b16 v[92:93], v147 offset:12288
    ds_read_b64_tr_b16 v[94:95], v147 offset:13312
    v_cvt_pk_bf16_f32 v25, v26, v27
    s_mul_i32 s40, s49, 0
    s_add_u32 s40, s40, s51
    buffer_store_dwordx2 v[24:25], v11, s[24:27], s40 offen sc1
    s_waitcnt lgkmcnt(10)
    v_mfma_f32_32x32x16_bf16 v[48:63], v[96:99], v[128:131], v[48:63]
    ds_read_b64_tr_b16 v[96:97], v147 offset:16384
    ds_read_b64_tr_b16 v[98:99], v147 offset:17408
    v_mul_f32 v28, v13, v28
    v_mul_f32 v29, v13, v29
    v_mul_f32 v30, v13, v30
    v_mul_f32 v31, v13, v31
    v_mul_f32 v32, v13, v32
    v_mul_f32 v33, v13, v33
    s_waitcnt lgkmcnt(10)
    v_mfma_f32_32x32x16_bf16 v[48:63], v[100:103], v[132:135], v[48:63]
    ds_read_b64_tr_b16 v[100:101], v147 offset:20480
    ds_read_b64_tr_b16 v[102:103], v147 offset:21504
    v_mul_f32 v34, v13, v34
    v_mul_f32 v35, v13, v35
    v_cvt_pk_bf16_f32 v28, v28, v29
    v_cvt_pk_bf16_f32 v29, v30, v31
    v_cvt_pk_bf16_f32 v30, v32, v33
    v_cvt_pk_bf16_f32 v31, v34, v35
    s_waitcnt lgkmcnt(10)
    v_mfma_f32_32x32x16_bf16 v[48:63], v[104:107], v[136:139], v[48:63]
    ds_read_b64_tr_b16 v[104:105], v147 offset:24576
    ds_read_b64_tr_b16 v[106:107], v147 offset:25600
    s_mul_i32 s40, s49, 1
    s_add_u32 s40, s40, s50
    buffer_store_dwordx4 v[28:31], v10, s[24:27], s40 offen sc1
    v_mul_f32 v36, v13, v36
    v_mul_f32 v37, v13, v37
    v_mul_f32 v38, v13, v38
    v_mul_f32 v39, v13, v39
    v_mul_f32 v40, v13, v40
    s_waitcnt lgkmcnt(10)
    v_mfma_f32_32x32x16_bf16 v[48:63], v[108:111], v[156:159], v[48:63]
    ds_read_b64_tr_b16 v[108:109], v147 offset:28672
    ds_read_b64_tr_b16 v[110:111], v147 offset:29696
    v_mul_f32 v41, v13, v41
    v_mul_f32 v42, v13, v42
    v_mul_f32 v43, v13, v43
    v_cvt_pk_bf16_f32 v36, v36, v37
    v_cvt_pk_bf16_f32 v37, v38, v39
    v_cvt_pk_bf16_f32 v38, v40, v41
    v_mfma_f32_32x32x8bf16_1k v[64:79], v[166:167], v[14:15], v[64:79]
    s_waitcnt lgkmcnt(10)
    v_mfma_f32_32x32x16_bf16 v[64:79], v[88:91], v[120:123], v[64:79]
    v_cvt_pk_bf16_f32 v39, v42, v43
    s_mul_i32 s40, s49, 2
    s_add_u32 s40, s40, s50
    buffer_store_dwordx4 v[36:39], v10, s[24:27], s40 offen sc1
    v_mul_f32 v44, v13, v44
    v_mul_f32 v45, v13, v45
    v_mul_f32 v46, v13, v46
    v_mul_f32 v47, v13, v47
    s_waitcnt lgkmcnt(8)
    v_mfma_f32_32x32x16_bf16 v[64:79], v[92:95], v[124:127], v[64:79]
    v_cvt_pk_bf16_f32 v44, v44, v45
    v_cvt_pk_bf16_f32 v45, v46, v47
    s_mul_i32 s40, s49, 2
    s_add_u32 s40, s40, s51
    buffer_store_dwordx2 v[44:45], v11, s[24:27], s40 offen sc1
    s_waitcnt lgkmcnt(6)
    v_mfma_f32_32x32x16_bf16 v[64:79], v[96:99], v[128:131], v[64:79]
    v_mul_f32 v48, v13, v48
    v_mul_f32 v49, v13, v49
    v_mul_f32 v50, v13, v50
    v_mul_f32 v51, v13, v51
    v_mul_f32 v52, v13, v52
    v_mul_f32 v53, v13, v53
    s_waitcnt lgkmcnt(4)
    v_mfma_f32_32x32x16_bf16 v[64:79], v[100:103], v[132:135], v[64:79]
    v_mul_f32 v54, v13, v54
    v_mul_f32 v55, v13, v55
    v_cvt_pk_bf16_f32 v48, v48, v49
    v_cvt_pk_bf16_f32 v49, v50, v51
    v_cvt_pk_bf16_f32 v50, v52, v53
    v_cvt_pk_bf16_f32 v51, v54, v55
    s_waitcnt lgkmcnt(2)
    v_mfma_f32_32x32x16_bf16 v[64:79], v[104:107], v[136:139], v[64:79]
    s_mul_i32 s40, s49, 3
    s_add_u32 s40, s40, s50
    buffer_store_dwordx4 v[48:51], v10, s[24:27], s40 offen sc1
    v_mul_f32 v56, v13, v56
    v_mul_f32 v57, v13, v57
    v_mul_f32 v58, v13, v58
    v_mul_f32 v59, v13, v59
    v_mul_f32 v60, v13, v60
    s_waitcnt lgkmcnt(0)
    v_mfma_f32_32x32x16_bf16 v[64:79], v[108:111], v[156:159], v[64:79]
    v_mul_f32 v61, v13, v61
    v_mul_f32 v62, v13, v62
    v_mul_f32 v63, v13, v63
    v_cvt_pk_bf16_f32 v56, v56, v57
    v_cvt_pk_bf16_f32 v57, v58, v59
    v_cvt_pk_bf16_f32 v58, v60, v61
    v_cvt_pk_bf16_f32 v59, v62, v63
    s_mul_i32 s40, s49, 4
    s_add_u32 s40, s40, s50
    buffer_store_dwordx4 v[56:59], v10, s[24:27], s40 offen sc1
    s_nop 1
    v_pk_mul_f32 v[64:65], v[64:65], v[12:13] op_sel:[0,1] op_sel_hi:[1,1]
    v_pk_mul_f32 v[66:67], v[66:67], v[12:13] op_sel:[0,1] op_sel_hi:[1,1]
    v_cvt_pk_bf16_f32 v64, v64, v65
    v_cvt_pk_bf16_f32 v65, v66, v67
    s_mul_i32 s40, s49, 4
    s_add_u32 s40, s40, s51
    buffer_store_dwordx2 v[64:65], v11, s[24:27], s40 offen sc1
    v_pk_mul_f32 v[68:69], v[68:69], v[12:13] op_sel:[0,1] op_sel_hi:[1,1]
    v_pk_mul_f32 v[70:71], v[70:71], v[12:13] op_sel:[0,1] op_sel_hi:[1,1]
    v_pk_mul_f32 v[72:73], v[72:73], v[12:13] op_sel:[0,1] op_sel_hi:[1,1]
    v_pk_mul_f32 v[74:75], v[74:75], v[12:13] op_sel:[0,1] op_sel_hi:[1,1]
    v_cvt_pk_bf16_f32 v68, v68, v69
    v_cvt_pk_bf16_f32 v69, v70, v71
    v_cvt_pk_bf16_f32 v70, v72, v73
    v_cvt_pk_bf16_f32 v71, v74, v75
    s_mul_i32 s40, s49, 5
    s_add_u32 s40, s40, s50
    buffer_store_dwordx4 v[68:71], v10, s[24:27], s40 offen sc1
    v_pk_mul_f32 v[76:77], v[76:77], v[12:13] op_sel:[0,1] op_sel_hi:[1,1]
    v_pk_mul_f32 v[78:79], v[78:79], v[12:13] op_sel:[0,1] op_sel_hi:[1,1]
    v_cvt_pk_bf16_f32 v76, v76, v77
    v_cvt_pk_bf16_f32 v77, v78, v79
    v_mov_b32 v78, v76
    v_mov_b32 v79, v77
    s_mul_i32 s40, s49, 6
    s_add_u32 s40, s40, s50
    v_permlane32_swap_b32 v76, v78
    v_permlane32_swap_b32 v77, v79
    s_mov_b32 exec_hi, 0
    buffer_store_dwordx4 v[76:79], v10, s[24:27], s40 offen offset:0 sc1
    s_mov_b32 exec_hi, -1
    s_branch C2_GO
C1_T1:
    s_waitcnt lgkmcnt(9)
    v_mfma_f32_32x32x16_bf16 v[16:31], v[88:91], v[80:83], v[16:31]
    s_barrier
    ds_read_b64_tr_b16 v[88:89], v144 offset:8192
    ds_read_b64_tr_b16 v[90:91], v144 offset:9216
    ds_read_b128 v[120:123], v142 offset:0
    ds_read_b128 v[124:127], v143 offset:0
    v_mfma_f32_32x32x16_bf16 v[32:47], v[92:95], v[80:83], v[32:47]
    ds_read_b64_tr_b16 v[92:93], v144 offset:12288
    ds_read_b64_tr_b16 v[94:95], v144 offset:13312
    ds_read_b128 v[128:131], v140 offset:16384
    ds_read_b128 v[132:135], v141 offset:16384
    v_mfma_f32_32x32x16_bf16 v[48:63], v[96:99], v[80:83], v[48:63]
    ds_read_b64_tr_b16 v[96:97], v144 offset:16384
    ds_read_b64_tr_b16 v[98:99], v144 offset:17408
    ds_read_b128 v[136:139], v142 offset:16384
    ds_read_b128 v[156:159], v143 offset:16384
    v_mfma_f32_32x32x16_bf16 v[64:79], v[100:103], v[80:83], v[64:79]
    ds_read_b64_tr_b16 v[100:101], v144 offset:20480
    ds_read_b64_tr_b16 v[102:103], v144 offset:21504
    s_waitcnt lgkmcnt(14)
    v_mfma_f32_32x32x16_bf16 v[16:31], v[104:107], v[84:87], v[16:31]
    ds_read_b64_tr_b16 v[104:105], v144 offset:24576
    ds_read_b64_tr_b16 v[106:107], v144 offset:25600
    v_mfma_f32_32x32x16_bf16 v[32:47], v[108:111], v[84:87], v[32:47]
    ds_read_b64_tr_b16 v[108:109], v144 offset:28672
    ds_read_b64_tr_b16 v[110:111], v144 offset:29696
    v_mfma_f32_32x32x16_bf16 v[48:63], v[112:115], v[84:87], v[48:63]
    s_add_u32 s46, s46, 1
    s_cmp_eq_u32 s46, 3
    s_cselect_b32 s46, 0, s46
    s_cselect_b32 s45, s59, s39
    v_add_u32 v140, s45, v140
    v_add_u32 v141, s45, v141
    v_mfma_f32_32x32x16_bf16 v[64:79], v[116:119], v[84:87], v[64:79]
    v_add_u32 v142, s45, v142
    v_add_u32 v143, s45, v143
    s_waitcnt lgkmcnt(14)
    v_mfma_f32_32x32x16_bf16 v[16:31], v[88:91], v[120:123], v[16:31]
    ds_read_b64_tr_b16 v[88:89], v145 offset:8192
    ds_read_b64_tr_b16 v[90:91], v145 offset:9216
    s_waitcnt lgkmcnt(14)
    v_mfma_f32_32x32x16_bf16 v[16:31], v[92:95], v[124:127], v[16:31]
    ds_read_b64_tr_b16 v[92:93], v145 offset:12288
    ds_read_b64_tr_b16 v[94:95], v145 offset:13312
    s_waitcnt lgkmcnt(12)
    v_mfma_f32_32x32x16_bf16 v[16:31], v[96:99], v[128:131], v[16:31]
    ds_read_b64_tr_b16 v[96:97], v145 offset:16384
    ds_read_b64_tr_b16 v[98:99], v145 offset:17408
    s_waitcnt lgkmcnt(10)
    v_mfma_f32_32x32x16_bf16 v[16:31], v[100:103], v[132:135], v[16:31]
    ds_read_b64_tr_b16 v[100:101], v145 offset:20480
    ds_read_b64_tr_b16 v[102:103], v145 offset:21504
    s_waitcnt lgkmcnt(10)
    v_mfma_f32_32x32x16_bf16 v[16:31], v[104:107], v[136:139], v[16:31]
    ds_read_b64_tr_b16 v[104:105], v145 offset:24576
    ds_read_b64_tr_b16 v[106:107], v145 offset:25600
    s_waitcnt lgkmcnt(10)
    v_mfma_f32_32x32x16_bf16 v[16:31], v[108:111], v[156:159], v[16:31]
    ds_read_b64_tr_b16 v[108:109], v145 offset:28672
    ds_read_b64_tr_b16 v[110:111], v145 offset:29696
    s_barrier
    ds_read_b32 v14, v8 offset:512
    ds_read_b32 v12, v8
    ds_read_b64 v[160:161], v9 offset:0
    ds_read_b64 v[162:163], v9 offset:256
    ds_read_b64 v[164:165], v9 offset:512
    ds_read_b64 v[166:167], v9 offset:768
    s_waitcnt lgkmcnt(14)
    v_mfma_f32_32x32x16_bf16 v[32:47], v[88:91], v[120:123], v[32:47]
    ds_read_b64_tr_b16 v[88:89], v146 offset:8192
    ds_read_b64_tr_b16 v[90:91], v146 offset:9216
    s_waitcnt lgkmcnt(14)
    v_mfma_f32_32x32x16_bf16 v[32:47], v[92:95], v[124:127], v[32:47]
    s_waitcnt lgkmcnt(2)
    v_cndmask_b32 v14, 0, v14, s[56:57]
    v_mul_f32 v13, s53, v12
    v_and_b32 v15, 0xffff, v14
    ds_read_b64_tr_b16 v[92:93], v146 offset:12288
    ds_read_b64_tr_b16 v[94:95], v146 offset:13312
    v_mfma_f32_32x32x8bf16_1k v[16:31], v[160:161], v[14:15], v[16:31]
    v_mfma_f32_32x32x16_bf16 v[32:47], v[96:99], v[128:131], v[32:47]
    ds_read_b64_tr_b16 v[96:97], v146 offset:16384
    ds_read_b64_tr_b16 v[98:99], v146 offset:17408
    v_mfma_f32_32x32x8bf16_1k v[32:47], v[162:163], v[14:15], v[32:47]
    v_mfma_f32_32x32x16_bf16 v[32:47], v[100:103], v[132:135], v[32:47]
    ds_read_b64_tr_b16 v[100:101], v146 offset:20480
    ds_read_b64_tr_b16 v[102:103], v146 offset:21504
    v_mfma_f32_32x32x16_bf16 v[32:47], v[104:107], v[136:139], v[32:47]
    ds_read_b64_tr_b16 v[104:105], v146 offset:24576
    ds_read_b64_tr_b16 v[106:107], v146 offset:25600
    s_nop 1
    v_mul_f32 v16, v13, v16
    v_mul_f32 v17, v13, v17
    v_mul_f32 v18, v13, v18
    v_mul_f32 v19, v13, v19
    v_cvt_pk_bf16_f32 v16, v16, v17
    v_cvt_pk_bf16_f32 v17, v18, v19
    v_mfma_f32_32x32x16_bf16 v[32:47], v[108:111], v[156:159], v[32:47]
    ds_read_b64_tr_b16 v[108:109], v146 offset:28672
    ds_read_b64_tr_b16 v[110:111], v146 offset:29696
    v_mov_b32 v18, v16
    v_mov_b32 v19, v17
    s_mul_i32 s40, s49, 6
    s_add_u32 s40, s40, s50
    v_permlane32_swap_b32 v16, v18
    v_permlane32_swap_b32 v17, v19
    s_mov_b32 exec_hi, 0
    buffer_store_dwordx4 v[16:19], v10, s[24:27], s40 offen offset:512 sc1
    s_mov_b32 exec_hi, -1
    v_mul_f32 v20, v13, v20
    v_mul_f32 v21, v13, v21
    v_mul_f32 v22, v13, v22
    v_mul_f32 v23, v13, v23
    v_cvt_pk_bf16_f32 v20, v20, v21
    v_mfma_f32_32x32x8bf16_1k v[48:63], v[164:165], v[14:15], v[48:63]
    s_waitcnt lgkmcnt(10)
    v_mfma_f32_32x32x16_bf16 v[48:63], v[88:91], v[120:123], v[48:63]
    ds_read_b64_tr_b16 v[88:89], v147 offset:8192
    ds_read_b64_tr_b16 v[90:91], v147 offset:9216
    v_cvt_pk_bf16_f32 v21, v22, v23
    s_mul_i32 s40, s49, 6
    s_add_u32 s40, s40, s51
    buffer_store_dwordx2 v[20:21], v11, s[24:27], s40 offen sc1
    v_mul_f32 v24, v13, v24
    v_mul_f32 v25, v13, v25
    v_mul_f32 v26, v13, v26
    v_mul_f32 v27, v13, v27
    s_waitcnt lgkmcnt(10)
    v_mfma_f32_32x32x16_bf16 v[48:63], v[92:95], v[124:127], v[48:63]
    ds_read_b64_tr_b16 v[92:93], v147 offset:12288
    ds_read_b64_tr_b16 v[94:95], v147 offset:13312
    v_mul_f32 v28, v13, v28
    v_mul_f32 v29, v13, v29
    v_mul_f32 v30, v13, v30
    v_mul_f32 v31, v13, v31
    v_cvt_pk_bf16_f32 v24, v24, v25
    v_cvt_pk_bf16_f32 v25, v26, v27
    s_waitcnt lgkmcnt(10)
    v_mfma_f32_32x32x16_bf16 v[48:63], v[96:99], v[128:131], v[48:63]
    ds_read_b64_tr_b16 v[96:97], v147 offset:16384
    ds_read_b64_tr_b16 v[98:99], v147 offset:17408
    v_cvt_pk_bf16_f32 v26, v28, v29
    v_cvt_pk_bf16_f32 v27, v30, v31
    s_mul_i32 s40, s49, 7
    s_add_u32 s40, s40, s50
    buffer_store_dwordx4 v[24:27], v10, s[24:27], s40 offen sc1
    v_mul_f32 v32, v13, v32
    v_mul_f32 v33, v13, v33
    v_mul_f32 v34, v13, v34
    s_waitcnt lgkmcnt(10)
    v_mfma_f32_32x32x16_bf16 v[48:63], v[100:103], v[132:135], v[48:63]
    ds_read_b64_tr_b16 v[100:101], v147 offset:20480
    ds_read_b64_tr_b16 v[102:103], v147 offset:21504
    v_mul_f32 v35, v13, v35
    v_mul_f32 v36, v13, v36
    v_mul_f32 v37, v13, v37
    v_mul_f32 v38, v13, v38
    v_mul_f32 v39, v13, v39
    v_cvt_pk_bf16_f32 v32, v32, v33
    s_waitcnt lgkmcnt(10)
    v_mfma_f32_32x32x16_bf16 v[48:63], v[104:107], v[136:139], v[48:63]
    ds_read_b64_tr_b16 v[104:105], v147 offset:24576
    ds_read_b64_tr_b16 v[106:107], v147 offset:25600
    v_cvt_pk_bf16_f32 v33, v34, v35
    v_cvt_pk_bf16_f32 v34, v36, v37
    v_cvt_pk_bf16_f32 v35, v38, v39
    s_mul_i32 s40, s49, 8
    s_add_u32 s40, s40, s50
    buffer_store_dwordx4 v[32:35], v10, s[24:27], s40 offen sc1
    v_mul_f32 v40, v13, v40
    v_mul_f32 v41, v13, v41
    s_waitcnt lgkmcnt(10)
    v_mfma_f32_32x32x16_bf16 v[48:63], v[108:111], v[156:159], v[48:63]
    ds_read_b64_tr_b16 v[108:109], v147 offset:28672
    ds_read_b64_tr_b16 v[110:111], v147 offset:29696
    v_mul_f32 v42, v13, v42
    v_mul_f32 v43, v13, v43
    v_cvt_pk_bf16_f32 v40, v40, v41
    v_cvt_pk_bf16_f32 v41, v42, v43
    s_mul_i32 s40, s49, 8
    s_add_u32 s40, s40, s51
    buffer_store_dwordx2 v[40:41], v11, s[24:27], s40 offen sc1
    v_mfma_f32_32x32x8bf16_1k v[64:79], v[166:167], v[14:15], v[64:79]
    s_waitcnt lgkmcnt(10)
    v_mfma_f32_32x32x16_bf16 v[64:79], v[88:91], v[120:123], v[64:79]
    s_waitcnt lgkmcnt(8)
    v_mfma_f32_32x32x16_bf16 v[64:79], v[92:95], v[124:127], v[64:79]
    s_waitcnt lgkmcnt(6)
    v_mfma_f32_32x32x16_bf16 v[64:79], v[96:99], v[128:131], v[64:79]
    v_mul_f32 v44, v13, v44
    v_mul_f32 v45, v13, v45
    v_mul_f32 v46, v13, v46
    v_mul_f32 v47, v13, v47
    v_mul_f32 v48, v13, v48
    v_mul_f32 v49, v13, v49
    s_waitcnt lgkmcnt(4)
    v_mfma_f32_32x32x16_bf16 v[64:79], v[100:103], v[132:135], v[64:79]
    v_mul_f32 v50, v13, v50
    v_mul_f32 v51, v13, v51
    v_cvt_pk_bf16_f32 v44, v44, v45
    v_cvt_pk_bf16_f32 v45, v46, v47
    v_cvt_pk_bf16_f32 v46, v48, v49
    v_cvt_pk_bf16_f32 v47, v50, v51
    s_waitcnt lgkmcnt(2)
    v_mfma_f32_32x32x16_bf16 v[64:79], v[104:107], v[136:139], v[64:79]
    s_mul_i32 s40, s49, 9
    s_add_u32 s40, s40, s50
    buffer_store_dwordx4 v[44:47], v10, s[24:27], s40 offen sc1
    v_mul_f32 v52, v13, v52
    v_mul_f32 v53, v13, v53
    v_mul_f32 v54, v13, v54
    v_mul_f32 v55, v13, v55
    v_mul_f32 v56, v13, v56
    s_waitcnt lgkmcnt(0)
    v_mfma_f32_32x32x16_bf16 v[64:79], v[108:111], v[156:159], v[64:79]
    v_mul_f32 v57, v13, v57
    v_mul_f32 v58, v13, v58
    v_mul_f32 v59, v13, v59
    v_cvt_pk_bf16_f32 v52, v52, v53
    v_cvt_pk_bf16_f32 v53, v54, v55
    v_cvt_pk_bf16_f32 v54, v56, v57
    v_cvt_pk_bf16_f32 v55, v58, v59
    s_mul_i32 s40, s49, 10
    s_add_u32 s40, s40, s50
    buffer_store_dwordx4 v[52:55], v10, s[24:27], s40 offen sc1
    v_mul_f32 v60, v13, v60
    v_mul_f32 v61, v13, v61
    v_mul_f32 v62, v13, v62
    v_mul_f32 v63, v13, v63
    v_cvt_pk_bf16_f32 v60, v60, v61
    v_cvt_pk_bf16_f32 v61, v62, v63
    s_mul_i32 s40, s49, 10
    s_add_u32 s40, s40, s51
    buffer_store_dwordx2 v[60:61], v11, s[24:27], s40 offen sc1
    v_pk_mul_f32 v[64:65], v[64:65], v[12:13] op_sel:[0,1] op_sel_hi:[1,1]
    v_pk_mul_f32 v[66:67], v[66:67], v[12:13] op_sel:[0,1] op_sel_hi:[1,1]
    v_pk_mul_f32 v[68:69], v[68:69], v[12:13] op_sel:[0,1] op_sel_hi:[1,1]
    v_pk_mul_f32 v[70:71], v[70:71], v[12:13] op_sel:[0,1] op_sel_hi:[1,1]
    v_cvt_pk_bf16_f32 v64, v64, v65
    v_cvt_pk_bf16_f32 v65, v66, v67
    v_cvt_pk_bf16_f32 v66, v68, v69
    v_cvt_pk_bf16_f32 v67, v70, v71
    s_mul_i32 s40, s49, 11
    s_add_u32 s40, s40, s50
    buffer_store_dwordx4 v[64:67], v10, s[24:27], s40 offen sc1
    v_pk_mul_f32 v[72:73], v[72:73], v[12:13] op_sel:[0,1] op_sel_hi:[1,1]
    v_pk_mul_f32 v[74:75], v[74:75], v[12:13] op_sel:[0,1] op_sel_hi:[1,1]
    v_pk_mul_f32 v[76:77], v[76:77], v[12:13] op_sel:[0,1] op_sel_hi:[1,1]
    v_pk_mul_f32 v[78:79], v[78:79], v[12:13] op_sel:[0,1] op_sel_hi:[1,1]
    v_cvt_pk_bf16_f32 v72, v72, v73
    v_cvt_pk_bf16_f32 v73, v74, v75
    v_cvt_pk_bf16_f32 v74, v76, v77
    v_cvt_pk_bf16_f32 v75, v78, v79
    s_mul_i32 s40, s49, 12
    s_add_u32 s40, s40, s50
    buffer_store_dwordx4 v[72:75], v10, s[24:27], s40 offen sc1
    s_branch C2_GO
C1_T2:
    s_waitcnt lgkmcnt(9)
    v_mfma_f32_32x32x16_bf16 v[16:31], v[88:91], v[80:83], v[16:31]
    s_barrier
    ds_read_b64_tr_b16 v[88:89], v144 offset:8192
    ds_read_b64_tr_b16 v[90:91], v144 offset:9216
    ds_read_b128 v[120:123], v142 offset:0
    ds_read_b128 v[124:127], v143 offset:0
    v_mfma_f32_32x32x16_bf16 v[32:47], v[92:95], v[80:83], v[32:47]
    ds_read_b64_tr_b16 v[92:93], v144 offset:12288
    ds_read_b64_tr_b16 v[94:95], v144 offset:13312
    ds_read_b128 v[128:131], v140 offset:16384
    ds_read_b128 v[132:135], v141 offset:16384
    v_mfma_f32_32x32x16_bf16 v[48:63], v[96:99], v[80:83], v[48:63]
    ds_read_b64_tr_b16 v[96:97], v144 offset:16384
    ds_read_b64_tr_b16 v[98:99], v144 offset:17408
    ds_read_b128 v[136:139], v142 offset:16384
    ds_read_b128 v[156:159], v143 offset:16384
    v_mfma_f32_32x32x16_bf16 v[64:79], v[100:103], v[80:83], v[64:79]
    ds_read_b64_tr_b16 v[100:101], v144 offset:20480
    ds_read_b64_tr_b16 v[102:103], v144 offset:21504
    s_waitcnt lgkmcnt(14)
    v_mfma_f32_32x32x16_bf16 v[16:31], v[104:107], v[84:87], v[16:31]
    ds_read_b64_tr_b16 v[104:105], v144 offset:24576
    ds_read_b64_tr_b16 v[106:107], v144 offset:25600
    v_mfma_f32_32x32x16_bf16 v[32:47], v[108:111], v[84:87], v[32:47]
    ds_read_b64_tr_b16 v[108:109], v144 offset:28672
    ds_read_b64_tr_b16 v[110:111], v144 offset:29696
    v_mfma_f32_32x32x16_bf16 v[48:63], v[112:115], v[84:87], v[48:63]
    s_add_u32 s46, s46, 1
    s_cmp_eq_u32 s46, 3
    s_cselect_b32 s46, 0, s46
    s_cselect_b32 s45, s59, s39
    v_add_u32 v140, s45, v140
    v_add_u32 v141, s45, v141
    v_mfma_f32_32x32x16_bf16 v[64:79], v[116:119], v[84:87], v[64:79]
    v_add_u32 v142, s45, v142
    v_add_u32 v143, s45, v143
    s_waitcnt lgkmcnt(14)
    v_mfma_f32_32x32x16_bf16 v[16:31], v[88:91], v[120:123], v[16:31]
    ds_read_b64_tr_b16 v[88:89], v145 offset:8192
    ds_read_b64_tr_b16 v[90:91], v145 offset:9216
    s_waitcnt lgkmcnt(14)
    v_mfma_f32_32x32x16_bf16 v[16:31], v[92:95], v[124:127], v[16:31]
    ds_read_b64_tr_b16 v[92:93], v145 offset:12288
    ds_read_b64_tr_b16 v[94:95], v145 offset:13312
    s_waitcnt lgkmcnt(12)
    v_mfma_f32_32x32x16_bf16 v[16:31], v[96:99], v[128:131], v[16:31]
    ds_read_b64_tr_b16 v[96:97], v145 offset:16384
    ds_read_b64_tr_b16 v[98:99], v145 offset:17408
    s_waitcnt lgkmcnt(10)
    v_mfma_f32_32x32x16_bf16 v[16:31], v[100:103], v[132:135], v[16:31]
    ds_read_b64_tr_b16 v[100:101], v145 offset:20480
    ds_read_b64_tr_b16 v[102:103], v145 offset:21504
    s_waitcnt lgkmcnt(10)
    v_mfma_f32_32x32x16_bf16 v[16:31], v[104:107], v[136:139], v[16:31]
    ds_read_b64_tr_b16 v[104:105], v145 offset:24576
    ds_read_b64_tr_b16 v[106:107], v145 offset:25600
    s_waitcnt lgkmcnt(10)
    v_mfma_f32_32x32x16_bf16 v[16:31], v[108:111], v[156:159], v[16:31]
    ds_read_b64_tr_b16 v[108:109], v145 offset:28672
    ds_read_b64_tr_b16 v[110:111], v145 offset:29696
    s_barrier
    ds_read_b32 v14, v8 offset:512
    ds_read_b32 v12, v8
    ds_read_b64 v[160:161], v9 offset:0
    ds_read_b64 v[162:163], v9 offset:256
    ds_read_b64 v[164:165], v9 offset:512
    ds_read_b64 v[166:167], v9 offset:768
    s_waitcnt lgkmcnt(14)
    v_mfma_f32_32x32x16_bf16 v[32:47], v[88:91], v[120:123], v[32:47]
    ds_read_b64_tr_b16 v[88:89], v146 offset:8192
    ds_read_b64_tr_b16 v[90:91], v146 offset:9216
    s_waitcnt lgkmcnt(14)
    v_mfma_f32_32x32x16_bf16 v[32:47], v[92:95], v[124:127], v[32:47]
    s_waitcnt lgkmcnt(2)
    v_cndmask_b32 v14, 0, v14, s[56:57]
    v_mul_f32 v13, s53, v12
    v_and_b32 v15, 0xffff, v14
    ds_read_b64_tr_b16 v[92:93], v146 offset:12288
    ds_read_b64_tr_b16 v[94:95], v146 offset:13312
    v_mfma_f32_32x32x8bf16_1k v[16:31], v[160:161], v[14:15], v[16:31]
    v_mfma_f32_32x32x16_bf16 v[32:47], v[96:99], v[128:131], v[32:47]
    ds_read_b64_tr_b16 v[96:97], v146 offset:16384
    ds_read_b64_tr_b16 v[98:99], v146 offset:17408
    v_mfma_f32_32x32x8bf16_1k v[32:47], v[162:163], v[14:15], v[32:47]
    v_mfma_f32_32x32x16_bf16 v[32:47], v[100:103], v[132:135], v[32:47]
    ds_read_b64_tr_b16 v[100:101], v146 offset:20480
    ds_read_b64_tr_b16 v[102:103], v146 offset:21504
    v_mfma_f32_32x32x16_bf16 v[32:47], v[104:107], v[136:139], v[32:47]
    ds_read_b64_tr_b16 v[104:105], v146 offset:24576
    ds_read_b64_tr_b16 v[106:107], v146 offset:25600
    s_nop 1
    v_mul_f32 v16, v13, v16
    v_mul_f32 v17, v13, v17
    v_mul_f32 v18, v13, v18
    v_mul_f32 v19, v13, v19
    v_cvt_pk_bf16_f32 v16, v16, v17
    v_cvt_pk_bf16_f32 v17, v18, v19
    v_mfma_f32_32x32x16_bf16 v[32:47], v[108:111], v[156:159], v[32:47]
    ds_read_b64_tr_b16 v[108:109], v146 offset:28672
    ds_read_b64_tr_b16 v[110:111], v146 offset:29696
    s_mul_i32 s40, s49, 12
    s_add_u32 s40, s40, s51
    buffer_store_dwordx2 v[16:17], v11, s[24:27], s40 offen sc1
    v_mul_f32 v20, v13, v20
    v_mul_f32 v21, v13, v21
    v_mul_f32 v22, v13, v22
    v_mul_f32 v23, v13, v23
    v_mul_f32 v24, v13, v24
    v_mfma_f32_32x32x8bf16_1k v[48:63], v[164:165], v[14:15], v[48:63]
    s_waitcnt lgkmcnt(10)
    v_mfma_f32_32x32x16_bf16 v[48:63], v[88:91], v[120:123], v[48:63]
    ds_read_b64_tr_b16 v[88:89], v147 offset:8192
    ds_read_b64_tr_b16 v[90:91], v147 offset:9216
    v_mul_f32 v25, v13, v25
    v_mul_f32 v26, v13, v26
    v_mul_f32 v27, v13, v27
    v_cvt_pk_bf16_f32 v20, v20, v21
    v_cvt_pk_bf16_f32 v21, v22, v23
    v_cvt_pk_bf16_f32 v22, v24, v25
    s_waitcnt lgkmcnt(10)
    v_mfma_f32_32x32x16_bf16 v[48:63], v[92:95], v[124:127], v[48:63]
    ds_read_b64_tr_b16 v[92:93], v147 offset:12288
    ds_read_b64_tr_b16 v[94:95], v147 offset:13312
    v_cvt_pk_bf16_f32 v23, v26, v27
    s_mul_i32 s40, s49, 13
    s_add_u32 s40, s40, s50
    buffer_store_dwordx4 v[20:23], v10, s[24:27], s40 offen sc1
    s_waitcnt lgkmcnt(10)
    v_mfma_f32_32x32x16_bf16 v[48:63], v[96:99], v[128:131], v[48:63]
    ds_read_b64_tr_b16 v[96:97], v147 offset:16384
    ds_read_b64_tr_b16 v[98:99], v147 offset:17408
    v_mul_f32 v28, v13, v28
    v_mul_f32 v29, v13, v29
    v_mul_f32 v30, v13, v30
    v_mul_f32 v31, v13, v31
    v_mul_f32 v32, v13, v32
    v_mul_f32 v33, v13, v33
    s_waitcnt lgkmcnt(10)
    v_mfma_f32_32x32x16_bf16 v[48:63], v[100:103], v[132:135], v[48:63]
    ds_read_b64_tr_b16 v[100:101], v147 offset:20480
    ds_read_b64_tr_b16 v[102:103], v147 offset:21504
    v_mul_f32 v34, v13, v34
    v_mul_f32 v35, v13, v35
    v_cvt_pk_bf16_f32 v28, v28, v29
    v_cvt_pk_bf16_f32 v29, v30, v31
    v_cvt_pk_bf16_f32 v30, v32, v33
    v_cvt_pk_bf16_f32 v31, v34, v35
    s_waitcnt lgkmcnt(10)
    v_mfma_f32_32x32x16_bf16 v[48:63], v[104:107], v[136:139], v[48:63]
    ds_read_b64_tr_b16 v[104:105], v147 offset:24576
    ds_read_b64_tr_b16 v[106:107], v147 offset:25600
    s_mul_i32 s40, s49, 14
    s_add_u32 s40, s40, s50
    buffer_store_dwordx4 v[28:31], v10, s[24:27], s40 offen sc1
    v_mul_f32 v36, v13, v36
    v_mul_f32 v37, v13, v37
    v_mul_f32 v38, v13, v38
    v_mul_f32 v39, v13, v39
    v_cvt_pk_bf16_f32 v36, v36, v37
    s_waitcnt lgkmcnt(10)
    v_mfma_f32_32x32x16_bf16 v[48:63], v[108:111], v[156:159], v[48:63]
    ds_read_b64_tr_b16 v[108:109], v147 offset:28672
    ds_read_b64_tr_b16 v[110:111], v147 offset:29696
    v_cvt_pk_bf16_f32 v37, v38, v39
    s_mul_i32 s40, s49, 14
    s_add_u32 s40, s40, s51
    buffer_store_dwordx2 v[36:37], v11, s[24:27], s40 offen sc1
    v_mul_f32 v40, v13, v40
    v_mul_f32 v41, v13, v41
    v_mul_f32 v42, v13, v42
    v_mul_f32 v43, v13, v43
    v_mfma_f32_32x32x8bf16_1k v[64:79], v[166:167], v[14:15], v[64:79]
    s_waitcnt lgkmcnt(10)
    v_mfma_f32_32x32x16_bf16 v[64:79], v[88:91], v[120:123], v[64:79]
    v_mul_f32 v44, v13, v44
    v_mul_f32 v45, v13, v45
    v_mul_f32 v46, v13, v46
    v_mul_f32 v47, v13, v47
    v_cvt_pk_bf16_f32 v40, v40, v41
    v_cvt_pk_bf16_f32 v41, v42, v43
    s_waitcnt lgkmcnt(8)
    v_mfma_f32_32x32x16_bf16 v[64:79], v[92:95], v[124:127], v[64:79]
    v_cvt_pk_bf16_f32 v42, v44, v45
    v_cvt_pk_bf16_f32 v43, v46, v47
    s_mul_i32 s40, s49, 15
    s_add_u32 s40, s40, s50
    buffer_store_dwordx4 v[40:43], v10, s[24:27], s40 offen sc1
    s_waitcnt lgkmcnt(6)
    v_mfma_f32_32x32x16_bf16 v[64:79], v[96:99], v[128:131], v[64:79]
    v_mul_f32 v48, v13, v48
    v_mul_f32 v49, v13, v49
    v_mul_f32 v50, v13, v50
    v_mul_f32 v51, v13, v51
    v_mul_f32 v52, v13, v52
    v_mul_f32 v53, v13, v53
    s_waitcnt lgkmcnt(4)
    v_mfma_f32_32x32x16_bf16 v[64:79], v[100:103], v[132:135], v[64:79]
    v_mul_f32 v54, v13, v54
    v_mul_f32 v55, v13, v55
    v_cvt_pk_bf16_f32 v48, v48, v49
    v_cvt_pk_bf16_f32 v49, v50, v51
    v_cvt_pk_bf16_f32 v50, v52, v53
    v_cvt_pk_bf16_f32 v51, v54, v55
    s_waitcnt lgkmcnt(2)
    v_mfma_f32_32x32x16_bf16 v[64:79], v[104:107], v[136:139], v[64:79]
    s_mul_i32 s40, s49, 16
    s_add_u32 s40, s40, s50
    buffer_store_dwordx4 v[48:51], v10, s[24:27], s40 offen sc1
    v_mul_f32 v56, v13, v56
    v_mul_f32 v57, v13, v57
    v_mul_f32 v58, v13, v58
    v_mul_f32 v59, v13, v59
    v_cvt_pk_bf16_f32 v56, v56, v57
    s_waitcnt lgkmcnt(0)
    v_mfma_f32_32x32x16_bf16 v[64:79], v[108:111], v[156:159], v[64:79]
    v_cvt_pk_bf16_f32 v57, v58, v59
    s_mul_i32 s40, s49, 16
    s_add_u32 s40, s40, s51
    buffer_store_dwordx2 v[56:57], v11, s[24:27], s40 offen sc1
    v_pk_mul_f32 v[60:61], v[60:61], v[12:13] op_sel:[0,1] op_sel_hi:[1,1]
    v_pk_mul_f32 v[62:63], v[62:63], v[12:13] op_sel:[0,1] op_sel_hi:[1,1]
    s_nop 5
    v_pk_mul_f32 v[64:65], v[64:65], v[12:13] op_sel:[0,1] op_sel_hi:[1,1]
    v_pk_mul_f32 v[66:67], v[66:67], v[12:13] op_sel:[0,1] op_sel_hi:[1,1]
    v_cvt_pk_bf16_f32 v60, v60, v61
    v_cvt_pk_bf16_f32 v61, v62, v63
    v_cvt_pk_bf16_f32 v62, v64, v65
    v_cvt_pk_bf16_f32 v63, v66, v67
    s_mul_i32 s40, s49, 17
    s_add_u32 s40, s40, s50
    buffer_store_dwordx4 v[60:63], v10, s[24:27], s40 offen sc1
    v_pk_mul_f32 v[68:69], v[68:69], v[12:13] op_sel:[0,1] op_sel_hi:[1,1]
    v_pk_mul_f32 v[70:71], v[70:71], v[12:13] op_sel:[0,1] op_sel_hi:[1,1]
    v_pk_mul_f32 v[72:73], v[72:73], v[12:13] op_sel:[0,1] op_sel_hi:[1,1]
    v_pk_mul_f32 v[74:75], v[74:75], v[12:13] op_sel:[0,1] op_sel_hi:[1,1]
    v_cvt_pk_bf16_f32 v68, v68, v69
    v_cvt_pk_bf16_f32 v69, v70, v71
    v_cvt_pk_bf16_f32 v70, v72, v73
    v_cvt_pk_bf16_f32 v71, v74, v75
    s_mul_i32 s40, s49, 18
    s_add_u32 s40, s40, s50
    buffer_store_dwordx4 v[68:71], v10, s[24:27], s40 offen sc1
    v_pk_mul_f32 v[76:77], v[76:77], v[12:13] op_sel:[0,1] op_sel_hi:[1,1]
    v_pk_mul_f32 v[78:79], v[78:79], v[12:13] op_sel:[0,1] op_sel_hi:[1,1]
    v_cvt_pk_bf16_f32 v76, v76, v77
    v_cvt_pk_bf16_f32 v77, v78, v79
    s_mul_i32 s40, s49, 18
    s_add_u32 s40, s40, s51
    buffer_store_dwordx2 v[76:77], v11, s[24:27], s40 offen sc1
    s_branch C2_GO
C1_T3:
    s_waitcnt lgkmcnt(9)
    v_mfma_f32_32x32x16_bf16 v[16:31], v[88:91], v[80:83], v[16:31]
    s_barrier
    ds_read_b64_tr_b16 v[88:89], v144 offset:8192
    ds_read_b64_tr_b16 v[90:91], v144 offset:9216
    ds_read_b128 v[120:123], v142 offset:0
    ds_read_b128 v[124:127], v143 offset:0
    v_mfma_f32_32x32x16_bf16 v[32:47], v[92:95], v[80:83], v[32:47]
    ds_read_b64_tr_b16 v[92:93], v144 offset:12288
    ds_read_b64_tr_b16 v[94:95], v144 offset:13312
    ds_read_b128 v[128:131], v140 offset:16384
    ds_read_b128 v[132:135], v141 offset:16384
    v_mfma_f32_32x32x16_bf16 v[48:63], v[96:99], v[80:83], v[48:63]
    ds_read_b64_tr_b16 v[96:97], v144 offset:16384
    ds_read_b64_tr_b16 v[98:99], v144 offset:17408
    ds_read_b128 v[136:139], v142 offset:16384
    ds_read_b128 v[156:159], v143 offset:16384
    v_mfma_f32_32x32x16_bf16 v[64:79], v[100:103], v[80:83], v[64:79]
    ds_read_b64_tr_b16 v[100:101], v144 offset:20480
    ds_read_b64_tr_b16 v[102:103], v144 offset:21504
    s_waitcnt lgkmcnt(14)
    v_mfma_f32_32x32x16_bf16 v[16:31], v[104:107], v[84:87], v[16:31]
    ds_read_b64_tr_b16 v[104:105], v144 offset:24576
    ds_read_b64_tr_b16 v[106:107], v144 offset:25600
    v_mfma_f32_32x32x16_bf16 v[32:47], v[108:111], v[84:87], v[32:47]
    ds_read_b64_tr_b16 v[108:109], v144 offset:28672
    ds_read_b64_tr_b16 v[110:111], v144 offset:29696
    v_mfma_f32_32x32x16_bf16 v[48:63], v[112:115], v[84:87], v[48:63]
    s_add_u32 s46, s46, 1
    s_cmp_eq_u32 s46, 3
    s_cselect_b32 s46, 0, s46
    s_cselect_b32 s45, s59, s39
    v_add_u32 v140, s45, v140
    v_add_u32 v141, s45, v141
    v_mfma_f32_32x32x16_bf16 v[64:79], v[116:119], v[84:87], v[64:79]
    v_add_u32 v142, s45, v142
    v_add_u32 v143, s45, v143
    s_waitcnt lgkmcnt(14)
    v_mfma_f32_32x32x16_bf16 v[16:31], v[88:91], v[120:123], v[16:31]
    ds_read_b64_tr_b16 v[88:89], v145 offset:8192
    ds_read_b64_tr_b16 v[90:91], v145 offset:9216
    s_waitcnt lgkmcnt(14)
    v_mfma_f32_32x32x16_bf16 v[16:31], v[92:95], v[124:127], v[16:31]
    ds_read_b64_tr_b16 v[92:93], v145 offset:12288
    ds_read_b64_tr_b16 v[94:95], v145 offset:13312
    s_waitcnt lgkmcnt(12)
    v_mfma_f32_32x32x16_bf16 v[16:31], v[96:99], v[128:131], v[16:31]
    ds_read_b64_tr_b16 v[96:97], v145 offset:16384
    ds_read_b64_tr_b16 v[98:99], v145 offset:17408
    s_waitcnt lgkmcnt(10)
    v_mfma_f32_32x32x16_bf16 v[16:31], v[100:103], v[132:135], v[16:31]
    ds_read_b64_tr_b16 v[100:101], v145 offset:20480
    ds_read_b64_tr_b16 v[102:103], v145 offset:21504
    s_waitcnt lgkmcnt(10)
    v_mfma_f32_32x32x16_bf16 v[16:31], v[104:107], v[136:139], v[16:31]
    ds_read_b64_tr_b16 v[104:105], v145 offset:24576
    ds_read_b64_tr_b16 v[106:107], v145 offset:25600
    s_waitcnt lgkmcnt(10)
    v_mfma_f32_32x32x16_bf16 v[16:31], v[108:111], v[156:159], v[16:31]
    ds_read_b64_tr_b16 v[108:109], v145 offset:28672
    ds_read_b64_tr_b16 v[110:111], v145 offset:29696
    s_barrier
    ds_read_b32 v14, v8 offset:512
    ds_read_b32 v12, v8
    ds_read_b64 v[160:161], v9 offset:0
    ds_read_b64 v[162:163], v9 offset:256
    ds_read_b64 v[164:165], v9 offset:512
    ds_read_b64 v[166:167], v9 offset:768
    s_waitcnt lgkmcnt(14)
    v_mfma_f32_32x32x16_bf16 v[32:47], v[88:91], v[120:123], v[32:47]
    ds_read_b64_tr_b16 v[88:89], v146 offset:8192
    ds_read_b64_tr_b16 v[90:91], v146 offset:9216
    s_waitcnt lgkmcnt(14)
    v_mfma_f32_32x32x16_bf16 v[32:47], v[92:95], v[124:127], v[32:47]
    s_waitcnt lgkmcnt(2)
    v_cndmask_b32 v14, 0, v14, s[56:57]
    v_mul_f32 v13, s53, v12
    v_and_b32 v15, 0xffff, v14
    ds_read_b64_tr_b16 v[92:93], v146 offset:12288
    ds_read_b64_tr_b16 v[94:95], v146 offset:13312
    v_mfma_f32_32x32x8bf16_1k v[16:31], v[160:161], v[14:15], v[16:31]
    v_mfma_f32_32x32x16_bf16 v[32:47], v[96:99], v[128:131], v[32:47]
    ds_read_b64_tr_b16 v[96:97], v146 offset:16384
    ds_read_b64_tr_b16 v[98:99], v146 offset:17408
    v_mfma_f32_32x32x8bf16_1k v[32:47], v[162:163], v[14:15], v[32:47]
    v_mfma_f32_32x32x16_bf16 v[32:47], v[100:103], v[132:135], v[32:47]
    ds_read_b64_tr_b16 v[100:101], v146 offset:20480
    ds_read_b64_tr_b16 v[102:103], v146 offset:21504
    v_mfma_f32_32x32x16_bf16 v[32:47], v[104:107], v[136:139], v[32:47]
    ds_read_b64_tr_b16 v[104:105], v146 offset:24576
    ds_read_b64_tr_b16 v[106:107], v146 offset:25600
    s_nop 1
    v_mul_f32 v16, v13, v16
    v_mul_f32 v17, v13, v17
    v_mul_f32 v18, v13, v18
    v_mul_f32 v19, v13, v19
    v_mul_f32 v20, v13, v20
    v_mul_f32 v21, v13, v21
    v_mfma_f32_32x32x16_bf16 v[32:47], v[108:111], v[156:159], v[32:47]
    ds_read_b64_tr_b16 v[108:109], v146 offset:28672
    ds_read_b64_tr_b16 v[110:111], v146 offset:29696
    v_mul_f32 v22, v13, v22
    v_mul_f32 v23, v13, v23
    v_cvt_pk_bf16_f32 v16, v16, v17
    v_cvt_pk_bf16_f32 v17, v18, v19
    v_cvt_pk_bf16_f32 v18, v20, v21
    v_cvt_pk_bf16_f32 v19, v22, v23
    v_mfma_f32_32x32x8bf16_1k v[48:63], v[164:165], v[14:15], v[48:63]
    s_waitcnt lgkmcnt(10)
    v_mfma_f32_32x32x16_bf16 v[48:63], v[88:91], v[120:123], v[48:63]
    ds_read_b64_tr_b16 v[88:89], v147 offset:8192
    ds_read_b64_tr_b16 v[90:91], v147 offset:9216
    s_mul_i32 s40, s49, 19
    s_add_u32 s40, s40, s50
    buffer_store_dwordx4 v[16:19], v10, s[24:27], s40 offen sc1
    v_mul_f32 v24, v13, v24
    v_mul_f32 v25, v13, v25
    v_mul_f32 v26, v13, v26
    v_mul_f32 v27, v13, v27
    v_mul_f32 v28, v13, v28
    s_waitcnt lgkmcnt(10)
    v_mfma_f32_32x32x16_bf16 v[48:63], v[92:95], v[124:127], v[48:63]
    ds_read_b64_tr_b16 v[92:93], v147 offset:12288
    ds_read_b64_tr_b16 v[94:95], v147 offset:13312
    v_mul_f32 v29, v13, v29
    v_mul_f32 v30, v13, v30
    v_mul_f32 v31, v13, v31
    v_cvt_pk_bf16_f32 v24, v24, v25
    v_cvt_pk_bf16_f32 v25, v26, v27
    v_cvt_pk_bf16_f32 v26, v28, v29
    s_waitcnt lgkmcnt(10)
    v_mfma_f32_32x32x16_bf16 v[48:63], v[96:99], v[128:131], v[48:63]
    ds_read_b64_tr_b16 v[96:97], v147 offset:16384
    ds_read_b64_tr_b16 v[98:99], v147 offset:17408
    v_cvt_pk_bf16_f32 v27, v30, v31
    s_mul_i32 s40, s49, 20
    s_add_u32 s40, s40, s50
    buffer_store_dwordx4 v[24:27], v10, s[24:27], s40 offen sc1
    v_mul_f32 v32, v13, v32
    v_mul_f32 v33, v13, v33
    v_mul_f32 v34, v13, v34
    v_mul_f32 v35, v13, v35
    s_waitcnt lgkmcnt(10)
    v_mfma_f32_32x32x16_bf16 v[48:63], v[100:103], v[132:135], v[48:63]
    ds_read_b64_tr_b16 v[100:101], v147 offset:20480
    ds_read_b64_tr_b16 v[102:103], v147 offset:21504
    v_cvt_pk_bf16_f32 v32, v32, v33
    v_cvt_pk_bf16_f32 v33, v34, v35
    s_mul_i32 s40, s49, 20
    s_add_u32 s40, s40, s51
    buffer_store_dwordx2 v[32:33], v11, s[24:27], s40 offen sc1
    v_mul_f32 v36, v13, v36
    v_mul_f32 v37, v13, v37
    v_mul_f32 v38, v13, v38
    s_waitcnt lgkmcnt(10)
    v_mfma_f32_32x32x16_bf16 v[48:63], v[104:107], v[136:139], v[48:63]
    ds_read_b64_tr_b16 v[104:105], v147 offset:24576
    ds_read_b64_tr_b16 v[106:107], v147 offset:25600
    v_mul_f32 v39, v13, v39
    v_mul_f32 v40, v13, v40
    v_mul_f32 v41, v13, v41
    v_mul_f32 v42, v13, v42
    v_mul_f32 v43, v13, v43
    v_cvt_pk_bf16_f32 v36, v36, v37
    s_waitcnt lgkmcnt(10)
    v_mfma_f32_32x32x16_bf16 v[48:63], v[108:111], v[156:159], v[48:63]
    ds_read_b64_tr_b16 v[108:109], v147 offset:28672
    ds_read_b64_tr_b16 v[110:111], v147 offset:29696
    v_cvt_pk_bf16_f32 v37, v38, v39
    v_cvt_pk_bf16_f32 v38, v40, v41
    v_cvt_pk_bf16_f32 v39, v42, v43
    s_mul_i32 s40, s49, 21
    s_add_u32 s40, s40, s50
    buffer_store_dwordx4 v[36:39], v10, s[24:27], s40 offen sc1
    v_mfma_f32_32x32x8bf16_1k v[64:79], v[166:167], v[14:15], v[64:79]
    s_waitcnt lgkmcnt(10)
    v_mfma_f32_32x32x16_bf16 v[64:79], v[88:91], v[120:123], v[64:79]
    s_waitcnt lgkmcnt(8)
    v_mfma_f32_32x32x16_bf16 v[64:79], v[92:95], v[124:127], v[64:79]
    s_waitcnt lgkmcnt(6)
    v_mfma_f32_32x32x16_bf16 v[64:79], v[96:99], v[128:131], v[64:79]
    v_mul_f32 v44, v13, v44
    v_mul_f32 v45, v13, v45
    v_mul_f32 v46, v13, v46
    v_mul_f32 v47, v13, v47
    v_mul_f32 v48, v13, v48
    v_mul_f32 v49, v13, v49
    s_waitcnt lgkmcnt(4)
    v_mfma_f32_32x32x16_bf16 v[64:79], v[100:103], v[132:135], v[64:79]
    v_mul_f32 v50, v13, v50
    v_mul_f32 v51, v13, v51
    v_cvt_pk_bf16_f32 v44, v44, v45
    v_cvt_pk_bf16_f32 v45, v46, v47
    v_cvt_pk_bf16_f32 v46, v48, v49
    v_cvt_pk_bf16_f32 v47, v50, v51
    s_waitcnt lgkmcnt(2)
    v_mfma_f32_32x32x16_bf16 v[64:79], v[104:107], v[136:139], v[64:79]
    s_mul_i32 s40, s49, 22
    s_add_u32 s40, s40, s50
    buffer_store_dwordx4 v[44:47], v10, s[24:27], s40 offen sc1
    v_mul_f32 v52, v13, v52
    v_mul_f32 v53, v13, v53
    v_mul_f32 v54, v13, v54
    v_mul_f32 v55, v13, v55
    v_cvt_pk_bf16_f32 v52, v52, v53
    s_waitcnt lgkmcnt(0)
    v_mfma_f32_32x32x16_bf16 v[64:79], v[108:111], v[156:159], v[64:79]
    v_cvt_pk_bf16_f32 v53, v54, v55
    s_mul_i32 s40, s49, 22
    s_add_u32 s40, s40, s51
    buffer_store_dwordx2 v[52:53], v11, s[24:27], s40 offen sc1
    v_mul_f32 v56, v13, v56
    v_mul_f32 v57, v13, v57
    v_mul_f32 v58, v13, v58
    v_mul_f32 v59, v13, v59
    v_mul_f32 v60, v13, v60
    v_mul_f32 v61, v13, v61
    v_mul_f32 v62, v13, v62
    v_mul_f32 v63, v13, v63
    v_cvt_pk_bf16_f32 v56, v56, v57
    v_cvt_pk_bf16_f32 v57, v58, v59
    v_cvt_pk_bf16_f32 v58, v60, v61
    v_cvt_pk_bf16_f32 v59, v62, v63
    s_mul_i32 s40, s49, 23
    s_add_u32 s40, s40, s50
    buffer_store_dwordx4 v[56:59], v10, s[24:27], s40 offen sc1
    v_pk_mul_f32 v[64:65], v[64:65], v[12:13] op_sel:[0,1] op_sel_hi:[1,1]
    v_pk_mul_f32 v[66:67], v[66:67], v[12:13] op_sel:[0,1] op_sel_hi:[1,1]
    v_pk_mul_f32 v[68:69], v[68:69], v[12:13] op_sel:[0,1] op_sel_hi:[1,1]
    v_pk_mul_f32 v[70:71], v[70:71], v[12:13] op_sel:[0,1] op_sel_hi:[1,1]
    v_cvt_pk_bf16_f32 v64, v64, v65
    v_cvt_pk_bf16_f32 v65, v66, v67
    v_cvt_pk_bf16_f32 v66, v68, v69
    v_cvt_pk_bf16_f32 v67, v70, v71
    s_mul_i32 s40, s49, 24
    s_add_u32 s40, s40, s50
    buffer_store_dwordx4 v[64:67], v10, s[24:27], s40 offen sc1
    v_pk_mul_f32 v[72:73], v[72:73], v[12:13] op_sel:[0,1] op_sel_hi:[1,1]
    v_pk_mul_f32 v[74:75], v[74:75], v[12:13] op_sel:[0,1] op_sel_hi:[1,1]
    v_cvt_pk_bf16_f32 v72, v72, v73
    v_cvt_pk_bf16_f32 v73, v74, v75
    s_mul_i32 s40, s49, 24
    s_add_u32 s40, s40, s51
    buffer_store_dwordx2 v[72:73], v11, s[24:27], s40 offen sc1
    v_pk_mul_f32 v[76:77], v[76:77], v[12:13] op_sel:[0,1] op_sel_hi:[1,1]
    v_pk_mul_f32 v[78:79], v[78:79], v[12:13] op_sel:[0,1] op_sel_hi:[1,1]
    v_cvt_pk_bf16_f32 v76, v76, v77
    v_cvt_pk_bf16_f32 v77, v78, v79
    v_mov_b32 v78, v76
    v_mov_b32 v79, v77
    s_mul_i32 s40, s49, 25
    s_add_u32 s40, s40, s50
    v_permlane32_swap_b32 v76, v78
    v_permlane32_swap_b32 v77, v79
    s_mov_b32 exec_hi, 0
    buffer_store_dwordx4 v[76:79], v10, s[24:27], s40 offen offset:0 sc1
    s_mov_b32 exec_hi, -1
    s_branch C2_GO
C1_T4:
    s_waitcnt lgkmcnt(9)
    v_mfma_f32_32x32x16_bf16 v[16:31], v[88:91], v[80:83], v[16:31]
    s_barrier
    ds_read_b64_tr_b16 v[88:89], v144 offset:8192
    ds_read_b64_tr_b16 v[90:91], v144 offset:9216
    ds_read_b128 v[120:123], v142 offset:0
    ds_read_b128 v[124:127], v143 offset:0
    v_mfma_f32_32x32x16_bf16 v[32:47], v[92:95], v[80:83], v[32:47]
    ds_read_b64_tr_b16 v[92:93], v144 offset:12288
    ds_read_b64_tr_b16 v[94:95], v144 offset:13312
    ds_read_b128 v[128:131], v140 offset:16384
    ds_read_b128 v[132:135], v141 offset:16384
    v_mfma_f32_32x32x16_bf16 v[48:63], v[96:99], v[80:83], v[48:63]
    ds_read_b64_tr_b16 v[96:97], v144 offset:16384
    ds_read_b64_tr_b16 v[98:99], v144 offset:17408
    ds_read_b128 v[136:139], v142 offset:16384
    ds_read_b128 v[156:159], v143 offset:16384
    v_mfma_f32_32x32x16_bf16 v[64:79], v[100:103], v[80:83], v[64:79]
    ds_read_b64_tr_b16 v[100:101], v144 offset:20480
    ds_read_b64_tr_b16 v[102:103], v144 offset:21504
    s_waitcnt lgkmcnt(14)
    v_mfma_f32_32x32x16_bf16 v[16:31], v[104:107], v[84:87], v[16:31]
    ds_read_b64_tr_b16 v[104:105], v144 offset:24576
    ds_read_b64_tr_b16 v[106:107], v144 offset:25600
    v_mfma_f32_32x32x16_bf16 v[32:47], v[108:111], v[84:87], v[32:47]
    ds_read_b64_tr_b16 v[108:109], v144 offset:28672
    ds_read_b64_tr_b16 v[110:111], v144 offset:29696
    v_mfma_f32_32x32x16_bf16 v[48:63], v[112:115], v[84:87], v[48:63]
    s_add_u32 s46, s46, 1
    s_cmp_eq_u32 s46, 3
    s_cselect_b32 s46, 0, s46
    s_cselect_b32 s45, s59, s39
    v_add_u32 v140, s45, v140
    v_add_u32 v141, s45, v141
    v_mfma_f32_32x32x16_bf16 v[64:79], v[116:119], v[84:87], v[64:79]
    v_add_u32 v142, s45, v142
    v_add_u32 v143, s45, v143
    s_waitcnt lgkmcnt(14)
    v_mfma_f32_32x32x16_bf16 v[16:31], v[88:91], v[120:123], v[16:31]
    ds_read_b64_tr_b16 v[88:89], v145 offset:8192
    ds_read_b64_tr_b16 v[90:91], v145 offset:9216
    s_waitcnt lgkmcnt(14)
    v_mfma_f32_32x32x16_bf16 v[16:31], v[92:95], v[124:127], v[16:31]
    ds_read_b64_tr_b16 v[92:93], v145 offset:12288
    ds_read_b64_tr_b16 v[94:95], v145 offset:13312
    s_waitcnt lgkmcnt(12)
    v_mfma_f32_32x32x16_bf16 v[16:31], v[96:99], v[128:131], v[16:31]
    ds_read_b64_tr_b16 v[96:97], v145 offset:16384
    ds_read_b64_tr_b16 v[98:99], v145 offset:17408
    s_waitcnt lgkmcnt(10)
    v_mfma_f32_32x32x16_bf16 v[16:31], v[100:103], v[132:135], v[16:31]
    ds_read_b64_tr_b16 v[100:101], v145 offset:20480
    ds_read_b64_tr_b16 v[102:103], v145 offset:21504
    s_waitcnt lgkmcnt(10)
    v_mfma_f32_32x32x16_bf16 v[16:31], v[104:107], v[136:139], v[16:31]
    ds_read_b64_tr_b16 v[104:105], v145 offset:24576
    ds_read_b64_tr_b16 v[106:107], v145 offset:25600
    s_waitcnt lgkmcnt(10)
    v_mfma_f32_32x32x16_bf16 v[16:31], v[108:111], v[156:159], v[16:31]
    ds_read_b64_tr_b16 v[108:109], v145 offset:28672
    ds_read_b64_tr_b16 v[110:111], v145 offset:29696
    s_barrier
    ds_read_b32 v14, v8 offset:512
    ds_read_b32 v12, v8
    ds_read_b64 v[160:161], v9 offset:0
    ds_read_b64 v[162:163], v9 offset:256
    ds_read_b64 v[164:165], v9 offset:512
    ds_read_b64 v[166:167], v9 offset:768
    s_waitcnt lgkmcnt(14)
    v_mfma_f32_32x32x16_bf16 v[32:47], v[88:91], v[120:123], v[32:47]
    ds_read_b64_tr_b16 v[88:89], v146 offset:8192
    ds_read_b64_tr_b16 v[90:91], v146 offset:9216
    s_waitcnt lgkmcnt(14)
    v_mfma_f32_32x32x16_bf16 v[32:47], v[92:95], v[124:127], v[32:47]
    s_waitcnt lgkmcnt(2)
    v_cndmask_b32 v14, 0, v14, s[56:57]
    v_mul_f32 v13, s53, v12
    v_and_b32 v15, 0xffff, v14
    ds_read_b64_tr_b16 v[92:93], v146 offset:12288
    ds_read_b64_tr_b16 v[94:95], v146 offset:13312
    v_mfma_f32_32x32x8bf16_1k v[16:31], v[160:161], v[14:15], v[16:31]
    v_mfma_f32_32x32x16_bf16 v[32:47], v[96:99], v[128:131], v[32:47]
    ds_read_b64_tr_b16 v[96:97], v146 offset:16384
    ds_read_b64_tr_b16 v[98:99], v146 offset:17408
    v_mfma_f32_32x32x8bf16_1k v[32:47], v[162:163], v[14:15], v[32:47]
    v_mfma_f32_32x32x16_bf16 v[32:47], v[100:103], v[132:135], v[32:47]
    ds_read_b64_tr_b16 v[100:101], v146 offset:20480
    ds_read_b64_tr_b16 v[102:103], v146 offset:21504
    v_mfma_f32_32x32x16_bf16 v[32:47], v[104:107], v[136:139], v[32:47]
    ds_read_b64_tr_b16 v[104:105], v146 offset:24576
    ds_read_b64_tr_b16 v[106:107], v146 offset:25600
    s_nop 1
    v_mul_f32 v16, v13, v16
    v_mul_f32 v17, v13, v17
    v_mul_f32 v18, v13, v18
    v_mul_f32 v19, v13, v19
    v_cvt_pk_bf16_f32 v16, v16, v17
    v_cvt_pk_bf16_f32 v17, v18, v19
    v_mfma_f32_32x32x16_bf16 v[32:47], v[108:111], v[156:159], v[32:47]
    ds_read_b64_tr_b16 v[108:109], v146 offset:28672
    ds_read_b64_tr_b16 v[110:111], v146 offset:29696
    v_mov_b32 v18, v16
    v_mov_b32 v19, v17
    s_mul_i32 s40, s49, 25
    s_add_u32 s40, s40, s50
    v_permlane32_swap_b32 v16, v18
    v_permlane32_swap_b32 v17, v19
    s_mov_b32 exec_hi, 0
    buffer_store_dwordx4 v[16:19], v10, s[24:27], s40 offen offset:512 sc1
    s_mov_b32 exec_hi, -1
    v_mul_f32 v20, v13, v20
    v_mul_f32 v21, v13, v21
    v_mul_f32 v22, v13, v22
    v_mul_f32 v23, v13, v23
    v_mul_f32 v24, v13, v24
    v_mfma_f32_32x32x8bf16_1k v[48:63], v[164:165], v[14:15], v[48:63]
    s_waitcnt lgkmcnt(10)
    v_mfma_f32_32x32x16_bf16 v[48:63], v[88:91], v[120:123], v[48:63]
    ds_read_b64_tr_b16 v[88:89], v147 offset:8192
    ds_read_b64_tr_b16 v[90:91], v147 offset:9216
    v_mul_f32 v25, v13, v25
    v_mul_f32 v26, v13, v26
    v_mul_f32 v27, v13, v27
    v_cvt_pk_bf16_f32 v20, v20, v21
    v_cvt_pk_bf16_f32 v21, v22, v23
    v_cvt_pk_bf16_f32 v22, v24, v25
    s_waitcnt lgkmcnt(10)
    v_mfma_f32_32x32x16_bf16 v[48:63], v[92:95], v[124:127], v[48:63]
    ds_read_b64_tr_b16 v[92:93], v147 offset:12288
    ds_read_b64_tr_b16 v[94:95], v147 offset:13312
    v_cvt_pk_bf16_f32 v23, v26, v27
    s_mul_i32 s40, s49, 26
    s_add_u32 s40, s40, s50
    buffer_store_dwordx4 v[20:23], v10, s[24:27], s40 offen sc1
    v_mul_f32 v28, v13, v28
    v_mul_f32 v29, v13, v29
    v_mul_f32 v30, v13, v30
    v_mul_f32 v31, v13, v31
    s_waitcnt lgkmcnt(10)
    v_mfma_f32_32x32x16_bf16 v[48:63], v[96:99], v[128:131], v[48:63]
    ds_read_b64_tr_b16 v[96:97], v147 offset:16384
    ds_read_b64_tr_b16 v[98:99], v147 offset:17408
    v_cvt_pk_bf16_f32 v28, v28, v29
    v_cvt_pk_bf16_f32 v29, v30, v31
    s_mul_i32 s40, s49, 26
    s_add_u32 s40, s40, s51
    buffer_store_dwordx2 v[28:29], v11, s[24:27], s40 offen sc1
    v_mul_f32 v32, v13, v32
    v_mul_f32 v33, v13, v33
    v_mul_f32 v34, v13, v34
    s_waitcnt lgkmcnt(10)
    v_mfma_f32_32x32x16_bf16 v[48:63], v[100:103], v[132:135], v[48:63]
    ds_read_b64_tr_b16 v[100:101], v147 offset:20480
    ds_read_b64_tr_b16 v[102:103], v147 offset:21504
    v_mul_f32 v35, v13, v35
    v_mul_f32 v36, v13, v36
    v_mul_f32 v37, v13, v37
    v_mul_f32 v38, v13, v38
    v_mul_f32 v39, v13, v39
    v_cvt_pk_bf16_f32 v32, v32, v33
    s_waitcnt lgkmcnt(10)
    v_mfma_f32_32x32x16_bf16 v[48:63], v[104:107], v[136:139], v[48:63]
    ds_read_b64_tr_b16 v[104:105], v147 offset:24576
    ds_read_b64_tr_b16 v[106:107], v147 offset:25600
    v_cvt_pk_bf16_f32 v33, v34, v35
    v_cvt_pk_bf16_f32 v34, v36, v37
    v_cvt_pk_bf16_f32 v35, v38, v39
    s_mul_i32 s40, s49, 27
    s_add_u32 s40, s40, s50
    buffer_store_dwordx4 v[32:35], v10, s[24:27], s40 offen sc1
    v_mul_f32 v40, v13, v40
    v_mul_f32 v41, v13, v41
    s_waitcnt lgkmcnt(10)
    v_mfma_f32_32x32x16_bf16 v[48:63], v[108:111], v[156:159], v[48:63]
    ds_read_b64_tr_b16 v[108:109], v147 offset:28672
    ds_read_b64_tr_b16 v[110:111], v147 offset:29696
    v_mul_f32 v42, v13, v42
    v_mul_f32 v43, v13, v43
    v_mul_f32 v44, v13, v44
    v_mul_f32 v45, v13, v45
    v_mul_f32 v46, v13, v46
    v_mul_f32 v47, v13, v47
    v_mfma_f32_32x32x8bf16_1k v[64:79], v[166:167], v[14:15], v[64:79]
    s_waitcnt lgkmcnt(10)
    v_mfma_f32_32x32x16_bf16 v[64:79], v[88:91], v[120:123], v[64:79]
    v_cvt_pk_bf16_f32 v40, v40, v41
    v_cvt_pk_bf16_f32 v41, v42, v43
    v_cvt_pk_bf16_f32 v42, v44, v45
    v_cvt_pk_bf16_f32 v43, v46, v47
    s_mul_i32 s40, s49, 28
    s_add_u32 s40, s40, s50
    buffer_store_dwordx4 v[40:43], v10, s[24:27], s40 offen sc1
    s_waitcnt lgkmcnt(8)
    v_mfma_f32_32x32x16_bf16 v[64:79], v[92:95], v[124:127], v[64:79]
    s_waitcnt lgkmcnt(6)
    v_mfma_f32_32x32x16_bf16 v[64:79], v[96:99], v[128:131], v[64:79]
    v_mul_f32 v48, v13, v48
    v_mul_f32 v49, v13, v49
    v_mul_f32 v50, v13, v50
    v_mul_f32 v51, v13, v51
    v_cvt_pk_bf16_f32 v48, v48, v49
    v_cvt_pk_bf16_f32 v49, v50, v51
    s_waitcnt lgkmcnt(4)
    v_mfma_f32_32x32x16_bf16 v[64:79], v[100:103], v[132:135], v[64:79]
    s_mul_i32 s40, s49, 28
    s_add_u32 s40, s40, s51
    buffer_store_dwordx2 v[48:49], v11, s[24:27], s40 offen sc1
    v_mul_f32 v52, v13, v52
    v_mul_f32 v53, v13, v53
    v_mul_f32 v54, v13, v54
    v_mul_f32 v55, v13, v55
    v_mul_f32 v56, v13, v56
    s_waitcnt lgkmcnt(2)
    v_mfma_f32_32x32x16_bf16 v[64:79], v[104:107], v[136:139], v[64:79]
    v_mul_f32 v57, v13, v57
    v_mul_f32 v58, v13, v58
    v_mul_f32 v59, v13, v59
    v_cvt_pk_bf16_f32 v52, v52, v53
    v_cvt_pk_bf16_f32 v53, v54, v55
    v_cvt_pk_bf16_f32 v54, v56, v57
    s_waitcnt lgkmcnt(0)
    v_mfma_f32_32x32x16_bf16 v[64:79], v[108:111], v[156:159], v[64:79]
    v_cvt_pk_bf16_f32 v55, v58, v59
    s_mul_i32 s40, s49, 29
    s_add_u32 s40, s40, s50
    buffer_store_dwordx4 v[52:55], v10, s[24:27], s40 offen sc1
    v_pk_mul_f32 v[60:61], v[60:61], v[12:13] op_sel:[0,1] op_sel_hi:[1,1]
    v_pk_mul_f32 v[62:63], v[62:63], v[12:13] op_sel:[0,1] op_sel_hi:[1,1]
    s_nop 5
    v_pk_mul_f32 v[64:65], v[64:65], v[12:13] op_sel:[0,1] op_sel_hi:[1,1]
    v_pk_mul_f32 v[66:67], v[66:67], v[12:13] op_sel:[0,1] op_sel_hi:[1,1]
    v_cvt_pk_bf16_f32 v60, v60, v61
    v_cvt_pk_bf16_f32 v61, v62, v63
    v_cvt_pk_bf16_f32 v62, v64, v65
    v_cvt_pk_bf16_f32 v63, v66, v67
    s_mul_i32 s40, s49, 30
    s_add_u32 s40, s40, s50
    buffer_store_dwordx4 v[60:63], v10, s[24:27], s40 offen sc1
    v_pk_mul_f32 v[68:69], v[68:69], v[12:13] op_sel:[0,1] op_sel_hi:[1,1]
    v_pk_mul_f32 v[70:71], v[70:71], v[12:13] op_sel:[0,1] op_sel_hi:[1,1]
    v_cvt_pk_bf16_f32 v68, v68, v69
    v_cvt_pk_bf16_f32 v69, v70, v71
    s_mul_i32 s40, s49, 30
    s_add_u32 s40, s40, s51
    buffer_store_dwordx2 v[68:69], v11, s[24:27], s40 offen sc1
    v_pk_mul_f32 v[72:73], v[72:73], v[12:13] op_sel:[0,1] op_sel_hi:[1,1]
    v_pk_mul_f32 v[74:75], v[74:75], v[12:13] op_sel:[0,1] op_sel_hi:[1,1]
    v_pk_mul_f32 v[76:77], v[76:77], v[12:13] op_sel:[0,1] op_sel_hi:[1,1]
    v_pk_mul_f32 v[78:79], v[78:79], v[12:13] op_sel:[0,1] op_sel_hi:[1,1]
    v_cvt_pk_bf16_f32 v72, v72, v73
    v_cvt_pk_bf16_f32 v73, v74, v75
    v_cvt_pk_bf16_f32 v74, v76, v77
    v_cvt_pk_bf16_f32 v75, v78, v79
    s_mul_i32 s40, s49, 31
    s_add_u32 s40, s40, s50
    buffer_store_dwordx4 v[72:75], v10, s[24:27], s40 offen sc1
    s_branch C2_GO
C1_T5:
    s_waitcnt lgkmcnt(9)
    v_mfma_f32_32x32x16_bf16 v[16:31], v[80:83], v[88:91], v[16:31]
    s_barrier
    ds_read_b64_tr_b16 v[88:89], v144 offset:8192
    ds_read_b64_tr_b16 v[90:91], v144 offset:9216
    ds_read_b128 v[120:123], v142 offset:0
    ds_read_b128 v[124:127], v143 offset:0
    v_mfma_f32_32x32x16_bf16 v[32:47], v[80:83], v[92:95], v[32:47]
    ds_read_b64_tr_b16 v[92:93], v144 offset:12288
    ds_read_b64_tr_b16 v[94:95], v144 offset:13312
    ds_read_b128 v[128:131], v140 offset:16384
    ds_read_b128 v[132:135], v141 offset:16384
    v_mfma_f32_32x32x16_bf16 v[48:63], v[80:83], v[96:99], v[48:63]
    ds_read_b64_tr_b16 v[96:97], v144 offset:16384
    ds_read_b64_tr_b16 v[98:99], v144 offset:17408
    ds_read_b128 v[136:139], v142 offset:16384
    ds_read_b128 v[156:159], v143 offset:16384
    v_mfma_f32_32x32x16_bf16 v[64:79], v[80:83], v[100:103], v[64:79]
    ds_read_b64_tr_b16 v[100:101], v144 offset:20480
    ds_read_b64_tr_b16 v[102:103], v144 offset:21504
    s_waitcnt lgkmcnt(14)
    v_mfma_f32_32x32x16_bf16 v[16:31], v[84:87], v[104:107], v[16:31]
    ds_read_b64_tr_b16 v[104:105], v144 offset:24576
    ds_read_b64_tr_b16 v[106:107], v144 offset:25600
    v_mfma_f32_32x32x16_bf16 v[32:47], v[84:87], v[108:111], v[32:47]
    ds_read_b64_tr_b16 v[108:109], v144 offset:28672
    ds_read_b64_tr_b16 v[110:111], v144 offset:29696
    v_mfma_f32_32x32x16_bf16 v[48:63], v[84:87], v[112:115], v[48:63]
    s_add_u32 s46, s46, 1
    s_cmp_eq_u32 s46, 3
    s_cselect_b32 s46, 0, s46
    s_cselect_b32 s45, s59, s39
    v_add_u32 v140, s45, v140
    v_add_u32 v141, s45, v141
    v_mfma_f32_32x32x16_bf16 v[64:79], v[84:87], v[116:119], v[64:79]
    v_add_u32 v142, s45, v142
    v_add_u32 v143, s45, v143
    s_waitcnt lgkmcnt(14)
    v_mfma_f32_32x32x16_bf16 v[16:31], v[120:123], v[88:91], v[16:31]
    ds_read_b64_tr_b16 v[88:89], v145 offset:8192
    ds_read_b64_tr_b16 v[90:91], v145 offset:9216
    s_waitcnt lgkmcnt(14)
    v_mfma_f32_32x32x16_bf16 v[16:31], v[124:127], v[92:95], v[16:31]
    ds_read_b64_tr_b16 v[92:93], v145 offset:12288
    ds_read_b64_tr_b16 v[94:95], v145 offset:13312
    s_waitcnt lgkmcnt(12)
    v_mfma_f32_32x32x16_bf16 v[16:31], v[128:131], v[96:99], v[16:31]
    ds_read_b64_tr_b16 v[96:97], v145 offset:16384
    ds_read_b64_tr_b16 v[98:99], v145 offset:17408
    s_waitcnt lgkmcnt(10)
    v_mfma_f32_32x32x16_bf16 v[16:31], v[132:135], v[100:103], v[16:31]
    ds_read_b64_tr_b16 v[100:101], v145 offset:20480
    ds_read_b64_tr_b16 v[102:103], v145 offset:21504
    s_waitcnt lgkmcnt(10)
    v_mfma_f32_32x32x16_bf16 v[16:31], v[136:139], v[104:107], v[16:31]
    ds_read_b64_tr_b16 v[104:105], v145 offset:24576
    ds_read_b64_tr_b16 v[106:107], v145 offset:25600
    s_waitcnt lgkmcnt(10)
    v_mfma_f32_32x32x16_bf16 v[16:31], v[156:159], v[108:111], v[16:31]
    ds_read_b64_tr_b16 v[108:109], v145 offset:28672
    ds_read_b64_tr_b16 v[110:111], v145 offset:29696
    s_barrier
    ds_read_b32 v14, v8 offset:512
    ds_read_b32 v12, v8
    ds_read_b64 v[160:161], v9 offset:0
    ds_read_b64 v[162:163], v9 offset:256
    ds_read_b64 v[164:165], v9 offset:512
    ds_read_b64 v[166:167], v9 offset:768
    ds_read_b128 v[80:83], v3 offset:0
    ds_read_b128 v[84:87], v3 offset:32
    ds_read_b128 v[112:115], v3 offset:64
    ds_read_b128 v[116:119], v3 offset:96
    s_waitcnt lgkmcnt(14)
    v_mfma_f32_32x32x16_bf16 v[32:47], v[120:123], v[88:91], v[32:47]
    ds_read_b64_tr_b16 v[88:89], v146 offset:8192
    ds_read_b64_tr_b16 v[90:91], v146 offset:9216
    s_waitcnt lgkmcnt(14)
    v_mfma_f32_32x32x16_bf16 v[32:47], v[124:127], v[92:95], v[32:47]
    s_waitcnt lgkmcnt(2)
    v_cndmask_b32 v14, 0, v14, s[56:57]
    v_mul_f32 v13, s53, v12
    v_and_b32 v15, 0xffff, v14
    ds_read_b64_tr_b16 v[92:93], v146 offset:12288
    ds_read_b64_tr_b16 v[94:95], v146 offset:13312
    v_mfma_f32_32x32x8bf16_1k v[16:31], v[14:15], v[160:161], v[16:31]
    v_mfma_f32_32x32x16_bf16 v[32:47], v[128:131], v[96:99], v[32:47]
    ds_read_b64_tr_b16 v[96:97], v146 offset:16384
    ds_read_b64_tr_b16 v[98:99], v146 offset:17408
    v_mfma_f32_32x32x8bf16_1k v[32:47], v[14:15], v[162:163], v[32:47]
    v_mfma_f32_32x32x16_bf16 v[32:47], v[132:135], v[100:103], v[32:47]
    ds_read_b64_tr_b16 v[100:101], v146 offset:20480
    ds_read_b64_tr_b16 v[102:103], v146 offset:21504
    v_mfma_f32_32x32x16_bf16 v[32:47], v[136:139], v[104:107], v[32:47]
    ds_read_b64_tr_b16 v[104:105], v146 offset:24576
    ds_read_b64_tr_b16 v[106:107], v146 offset:25600
    s_nop 1
    v_mul_f32 v16, v80, v16
    v_mul_f32 v17, v81, v17
    v_mul_f32 v18, v82, v18
    v_mul_f32 v19, v83, v19
    v_mul_f32 v20, v84, v20
    v_mul_f32 v21, v85, v21
    v_mfma_f32_32x32x16_bf16 v[32:47], v[156:159], v[108:111], v[32:47]
    ds_read_b64_tr_b16 v[108:109], v146 offset:28672
    ds_read_b64_tr_b16 v[110:111], v146 offset:29696
    v_mul_f32 v22, v86, v22
    v_mul_f32 v23, v87, v23
    v_cvt_pk_bf16_f32 v16, v16, v17
    v_cvt_pk_bf16_f32 v17, v18, v19
    v_cvt_pk_bf16_f32 v18, v20, v21
    v_cvt_pk_bf16_f32 v19, v22, v23
    v_mfma_f32_32x32x8bf16_1k v[48:63], v[14:15], v[164:165], v[48:63]
    s_waitcnt lgkmcnt(10)
    v_mfma_f32_32x32x16_bf16 v[48:63], v[120:123], v[88:91], v[48:63]
    ds_read_b64_tr_b16 v[88:89], v147 offset:8192
    ds_read_b64_tr_b16 v[90:91], v147 offset:9216
    buffer_store_dwordx4 v[16:19], v4, s[24:27], s52 offen offset:0 sc1
    v_mul_f32 v24, v112, v24
    v_mul_f32 v25, v113, v25
    v_mul_f32 v26, v114, v26
    v_mul_f32 v27, v115, v27
    v_mul_f32 v28, v116, v28
    s_waitcnt lgkmcnt(10)
    v_mfma_f32_32x32x16_bf16 v[48:63], v[124:127], v[92:95], v[48:63]
    ds_read_b64_tr_b16 v[92:93], v147 offset:12288
    ds_read_b64_tr_b16 v[94:95], v147 offset:13312
    v_mul_f32 v29, v117, v29
    v_mul_f32 v30, v118, v30
    v_mul_f32 v31, v119, v31
    v_cvt_pk_bf16_f32 v24, v24, v25
    v_cvt_pk_bf16_f32 v25, v26, v27
    v_cvt_pk_bf16_f32 v26, v28, v29
    s_waitcnt lgkmcnt(10)
    v_mfma_f32_32x32x16_bf16 v[48:63], v[128:131], v[96:99], v[48:63]
    ds_read_b64_tr_b16 v[96:97], v147 offset:16384
    ds_read_b64_tr_b16 v[98:99], v147 offset:17408
    v_cvt_pk_bf16_f32 v27, v30, v31
    buffer_store_dwordx4 v[24:27], v4, s[24:27], s52 offen offset:640 sc1
    v_mul_f32 v32, v80, v32
    v_mul_f32 v33, v81, v33
    v_mul_f32 v34, v82, v34
    v_mul_f32 v35, v83, v35
    s_waitcnt lgkmcnt(10)
    v_mfma_f32_32x32x16_bf16 v[48:63], v[132:135], v[100:103], v[48:63]
    ds_read_b64_tr_b16 v[100:101], v147 offset:20480
    ds_read_b64_tr_b16 v[102:103], v147 offset:21504
    v_mul_f32 v36, v84, v36
    v_mul_f32 v37, v85, v37
    v_mul_f32 v38, v86, v38
    v_mul_f32 v39, v87, v39
    v_cvt_pk_bf16_f32 v32, v32, v33
    v_cvt_pk_bf16_f32 v33, v34, v35
    s_waitcnt lgkmcnt(10)
    v_mfma_f32_32x32x16_bf16 v[48:63], v[136:139], v[104:107], v[48:63]
    ds_read_b64_tr_b16 v[104:105], v147 offset:24576
    ds_read_b64_tr_b16 v[106:107], v147 offset:25600
    v_cvt_pk_bf16_f32 v34, v36, v37
    v_cvt_pk_bf16_f32 v35, v38, v39
    buffer_store_dwordx4 v[32:35], v5, s[24:27], s52 offen offset:0 sc1
    v_mul_f32 v40, v112, v40
    v_mul_f32 v41, v113, v41
    v_mul_f32 v42, v114, v42
    s_waitcnt lgkmcnt(10)
    v_mfma_f32_32x32x16_bf16 v[48:63], v[156:159], v[108:111], v[48:63]
    ds_read_b64_tr_b16 v[108:109], v147 offset:28672
    ds_read_b64_tr_b16 v[110:111], v147 offset:29696
    v_mul_f32 v43, v115, v43
    v_mul_f32 v44, v116, v44
    v_mul_f32 v45, v117, v45
    v_mul_f32 v46, v118, v46
    v_mul_f32 v47, v119, v47
    v_cvt_pk_bf16_f32 v40, v40, v41
    v_mfma_f32_32x32x8bf16_1k v[64:79], v[14:15], v[166:167], v[64:79]
    s_waitcnt lgkmcnt(10)
    v_mfma_f32_32x32x16_bf16 v[64:79], v[120:123], v[88:91], v[64:79]
    v_cvt_pk_bf16_f32 v41, v42, v43
    v_cvt_pk_bf16_f32 v42, v44, v45
    v_cvt_pk_bf16_f32 v43, v46, v47
    buffer_store_dwordx4 v[40:43], v5, s[24:27], s52 offen offset:640 sc1
    s_waitcnt lgkmcnt(8)
    v_mfma_f32_32x32x16_bf16 v[64:79], v[124:127], v[92:95], v[64:79]
    s_waitcnt lgkmcnt(6)
    v_mfma_f32_32x32x16_bf16 v[64:79], v[128:131], v[96:99], v[64:79]
    v_mul_f32 v48, v80, v48
    v_mul_f32 v49, v81, v49
    v_mul_f32 v50, v82, v50
    v_mul_f32 v51, v83, v51
    v_mul_f32 v52, v84, v52
    v_mul_f32 v53, v85, v53
    s_waitcnt lgkmcnt(4)
    v_mfma_f32_32x32x16_bf16 v[64:79], v[132:135], v[100:103], v[64:79]
    v_mul_f32 v54, v86, v54
    v_mul_f32 v55, v87, v55
    v_cvt_pk_bf16_f32 v48, v48, v49
    v_cvt_pk_bf16_f32 v49, v50, v51
    v_cvt_pk_bf16_f32 v50, v52, v53
    v_cvt_pk_bf16_f32 v51, v54, v55
    s_waitcnt lgkmcnt(2)
    v_mfma_f32_32x32x16_bf16 v[64:79], v[136:139], v[104:107], v[64:79]
    buffer_store_dwordx4 v[48:51], v6, s[24:27], s52 offen offset:0 sc1
    v_mul_f32 v56, v112, v56
    v_mul_f32 v57, v113, v57
    v_mul_f32 v58, v114, v58
    v_mul_f32 v59, v115, v59
    v_mul_f32 v60, v116, v60
    s_waitcnt lgkmcnt(0)
    v_mfma_f32_32x32x16_bf16 v[64:79], v[156:159], v[108:111], v[64:79]
    v_mul_f32 v61, v117, v61
    v_mul_f32 v62, v118, v62
    v_mul_f32 v63, v119, v63
    v_cvt_pk_bf16_f32 v56, v56, v57
    v_cvt_pk_bf16_f32 v57, v58, v59
    v_cvt_pk_bf16_f32 v58, v60, v61
    v_cvt_pk_bf16_f32 v59, v62, v63
    buffer_store_dwordx4 v[56:59], v6, s[24:27], s52 offen offset:640 sc1
    s_nop 3
    v_pk_mul_f32 v[64:65], v[64:65], v[80:81]
    v_pk_mul_f32 v[66:67], v[66:67], v[82:83]
    v_pk_mul_f32 v[68:69], v[68:69], v[84:85]
    v_pk_mul_f32 v[70:71], v[70:71], v[86:87]
    v_cvt_pk_bf16_f32 v64, v64, v65
    v_cvt_pk_bf16_f32 v65, v66, v67
    v_cvt_pk_bf16_f32 v66, v68, v69
    v_cvt_pk_bf16_f32 v67, v70, v71
    buffer_store_dwordx4 v[64:67], v7, s[24:27], s52 offen offset:0 sc1
    v_pk_mul_f32 v[72:73], v[72:73], v[112:113]
    v_pk_mul_f32 v[74:75], v[74:75], v[114:115]
    v_pk_mul_f32 v[76:77], v[76:77], v[116:117]
    v_pk_mul_f32 v[78:79], v[78:79], v[118:119]
    v_cvt_pk_bf16_f32 v72, v72, v73
    v_cvt_pk_bf16_f32 v73, v74, v75
    v_cvt_pk_bf16_f32 v74, v76, v77
    v_cvt_pk_bf16_f32 v75, v78, v79
    buffer_store_dwordx4 v[72:75], v7, s[24:27], s52 offen offset:640 sc1
C2_GO:
    s_barrier
    ds_read_b128 v[80:83], v140 offset:0
    ds_read_b64_tr_b16 v[88:89], v148 offset:0
    ds_read_b64_tr_b16 v[90:91], v148 offset:768
    ds_read_b64_tr_b16 v[92:93], v148 offset:64
    ds_read_b64_tr_b16 v[94:95], v148 offset:832
    ds_read_b64_tr_b16 v[96:97], v148 offset:128
    ds_read_b64_tr_b16 v[98:99], v148 offset:896
    ds_read_b128 v[84:87], v141 offset:0
    ds_read_b64_tr_b16 v[104:105], v148 offset:3072
    ds_read_b64_tr_b16 v[106:107], v148 offset:3840
    ds_read_b64_tr_b16 v[108:109], v148 offset:3136
    ds_read_b64_tr_b16 v[110:111], v148 offset:3904
    ds_read_b64_tr_b16 v[112:113], v148 offset:3200
    ds_read_b64_tr_b16 v[114:115], v148 offset:3968
    v_mov_b32 v16, 0
    v_mov_b32 v17, 0
    v_mov_b32 v18, 0
    v_mov_b32 v19, 0
    v_mov_b32 v20, 0
    v_mov_b32 v21, 0
    v_mov_b32 v22, 0
    v_mov_b32 v23, 0
    v_mov_b32 v24, 0
    v_mov_b32 v25, 0
    v_mov_b32 v26, 0
    v_mov_b32 v27, 0
    v_mov_b32 v28, 0
    v_mov_b32 v29, 0
    v_mov_b32 v30, 0
    v_mov_b32 v31, 0
    v_mov_b32 v32, 0
    v_mov_b32 v33, 0
    v_mov_b32 v34, 0
    v_mov_b32 v35, 0
    v_mov_b32 v36, 0
    v_mov_b32 v37, 0
    v_mov_b32 v38, 0
    v_mov_b32 v39, 0
    v_mov_b32 v40, 0
    v_mov_b32 v41, 0
    v_mov_b32 v42, 0
    v_mov_b32 v43, 0
    v_mov_b32 v44, 0
    v_mov_b32 v45, 0
    v_mov_b32 v46, 0
    v_mov_b32 v47, 0
    v_mov_b32 v48, 0
    v_mov_b32 v49, 0
    v_mov_b32 v50, 0
    v_mov_b32 v51, 0
    v_mov_b32 v52, 0
    v_mov_b32 v53, 0
    v_mov_b32 v54, 0
    v_mov_b32 v55, 0
    v_mov_b32 v56, 0
    v_mov_b32 v57, 0
    v_mov_b32 v58, 0
    v_mov_b32 v59, 0
    v_mov_b32 v60, 0
    v_mov_b32 v61, 0
    v_mov_b32 v62, 0
    v_mov_b32 v63, 0
    s_mov_b32 s47, 5
C2_L:
    s_waitcnt lgkmcnt(7)
    v_mfma_f32_32x32x16_bf16 v[16:31], v[88:91], v[80:83], v[16:31]
    ds_read_b64_tr_b16 v[88:89], v148 offset:6144
    ds_read_b64_tr_b16 v[90:91], v148 offset:6912
    v_mfma_f32_32x32x16_bf16 v[32:47], v[92:95], v[80:83], v[32:47]
    ds_read_b64_tr_b16 v[92:93], v148 offset:6208
    ds_read_b64_tr_b16 v[94:95], v148 offset:6976
    v_mfma_f32_32x32x16_bf16 v[48:63], v[96:99], v[80:83], v[48:63]
    ds_read_b64_tr_b16 v[96:97], v148 offset:6272
    ds_read_b64_tr_b16 v[98:99], v148 offset:7040
    ds_read_b128 v[80:83], v142 offset:0
    s_waitcnt lgkmcnt(7)
    v_mfma_f32_32x32x16_bf16 v[16:31], v[104:107], v[84:87], v[16:31]
    ds_read_b64_tr_b16 v[104:105], v148 offset:9216
    ds_read_b64_tr_b16 v[106:107], v148 offset:9984
    v_mfma_f32_32x32x16_bf16 v[32:47], v[108:111], v[84:87], v[32:47]
    ds_read_b64_tr_b16 v[108:109], v148 offset:9280
    ds_read_b64_tr_b16 v[110:111], v148 offset:10048
    v_mfma_f32_32x32x16_bf16 v[48:63], v[112:115], v[84:87], v[48:63]
    ds_read_b64_tr_b16 v[112:113], v148 offset:9344
    ds_read_b64_tr_b16 v[114:115], v148 offset:10112
    ds_read_b128 v[84:87], v143 offset:0
    s_waitcnt lgkmcnt(7)
    v_mfma_f32_32x32x16_bf16 v[16:31], v[88:91], v[80:83], v[16:31]
    v_mfma_f32_32x32x16_bf16 v[32:47], v[92:95], v[80:83], v[32:47]
    s_waitcnt lgkmcnt(0)
    s_barrier
    v_mfma_f32_32x32x16_bf16 v[48:63], v[96:99], v[80:83], v[48:63]
    ds_read_b64_tr_b16 v[88:89], v148 offset:16384
    ds_read_b64_tr_b16 v[90:91], v148 offset:17152
    ds_read_b64_tr_b16 v[92:93], v148 offset:16448
    ds_read_b64_tr_b16 v[94:95], v148 offset:17216
    ds_read_b64_tr_b16 v[96:97], v148 offset:16512
    ds_read_b64_tr_b16 v[98:99], v148 offset:17280
    ds_read_b128 v[80:83], v140 offset:16384
    s_waitcnt lgkmcnt(7)
    v_mfma_f32_32x32x16_bf16 v[16:31], v[104:107], v[84:87], v[16:31]
    ds_read_b64_tr_b16 v[104:105], v148 offset:19456
    ds_read_b64_tr_b16 v[106:107], v148 offset:20224
    v_mfma_f32_32x32x16_bf16 v[32:47], v[108:111], v[84:87], v[32:47]
    ds_read_b64_tr_b16 v[108:109], v148 offset:19520
    ds_read_b64_tr_b16 v[110:111], v148 offset:20288
    v_mfma_f32_32x32x16_bf16 v[48:63], v[112:115], v[84:87], v[48:63]
    ds_read_b64_tr_b16 v[112:113], v148 offset:19584
    ds_read_b64_tr_b16 v[114:115], v148 offset:20352
    ds_read_b128 v[84:87], v141 offset:16384
    s_waitcnt lgkmcnt(7)
    v_mfma_f32_32x32x16_bf16 v[16:31], v[88:91], v[80:83], v[16:31]
    s_add_u32 s46, s46, 1
    s_cmp_eq_u32 s46, 3
    s_cselect_b32 s46, 0, s46
    s_cselect_b32 s45, s59, s39
    ds_read_b64_tr_b16 v[88:89], v148 offset:22528
    ds_read_b64_tr_b16 v[90:91], v148 offset:23296
    v_mfma_f32_32x32x16_bf16 v[32:47], v[92:95], v[80:83], v[32:47]
    ds_read_b64_tr_b16 v[92:93], v148 offset:22592
    ds_read_b64_tr_b16 v[94:95], v148 offset:23360
    v_mfma_f32_32x32x16_bf16 v[48:63], v[96:99], v[80:83], v[48:63]
    ds_read_b64_tr_b16 v[96:97], v148 offset:22656
    ds_read_b64_tr_b16 v[98:99], v148 offset:23424
    ds_read_b128 v[80:83], v142 offset:16384
    s_waitcnt lgkmcnt(7)
    v_mfma_f32_32x32x16_bf16 v[16:31], v[104:107], v[84:87], v[16:31]
    ds_read_b64_tr_b16 v[104:105], v148 offset:25600
    ds_read_b64_tr_b16 v[106:107], v148 offset:26368
    v_mfma_f32_32x32x16_bf16 v[32:47], v[108:111], v[84:87], v[32:47]
    ds_read_b64_tr_b16 v[108:109], v148 offset:25664
    ds_read_b64_tr_b16 v[110:111], v148 offset:26432
    v_mfma_f32_32x32x16_bf16 v[48:63], v[112:115], v[84:87], v[48:63]
    ds_read_b64_tr_b16 v[112:113], v148 offset:25728
    ds_read_b64_tr_b16 v[114:115], v148 offset:26496
    ds_read_b128 v[84:87], v143 offset:16384
    s_waitcnt lgkmcnt(7)
    v_mfma_f32_32x32x16_bf16 v[16:31], v[88:91], v[80:83], v[16:31]
    v_mfma_f32_32x32x16_bf16 v[32:47], v[92:95], v[80:83], v[32:47]
    s_waitcnt lgkmcnt(0)
    s_cmp_eq_u32 s47, 5
    s_cbranch_scc1 C2_L_D
C2_L_DR:
    s_cmp_eq_u32 s47, 1
    s_cbranch_scc1 C2_L_NB
    s_barrier
C2_L_NB:
    v_xor_b32 v148, 0x38000, v148
    v_mfma_f32_32x32x16_bf16 v[48:63], v[96:99], v[80:83], v[48:63]
    ds_read_b64_tr_b16 v[88:89], v148 offset:0
    ds_read_b64_tr_b16 v[90:91], v148 offset:768
    ds_read_b64_tr_b16 v[92:93], v148 offset:64
    ds_read_b64_tr_b16 v[94:95], v148 offset:832
    v_add_u32 v140, s45, v140
    ds_read_b64_tr_b16 v[96:97], v148 offset:128
    ds_read_b64_tr_b16 v[98:99], v148 offset:896
    ds_read_b128 v[80:83], v140 offset:0
    v_add_u32 v141, s45, v141
    v_add_u32 v142, s45, v142
    v_add_u32 v143, s45, v143
    s_waitcnt lgkmcnt(7)
    v_mfma_f32_32x32x16_bf16 v[16:31], v[104:107], v[84:87], v[16:31]
    ds_read_b64_tr_b16 v[104:105], v148 offset:3072
    ds_read_b64_tr_b16 v[106:107], v148 offset:3840
    v_mfma_f32_32x32x16_bf16 v[32:47], v[108:111], v[84:87], v[32:47]
    ds_read_b64_tr_b16 v[108:109], v148 offset:3136
    ds_read_b64_tr_b16 v[110:111], v148 offset:3904
    v_mfma_f32_32x32x16_bf16 v[48:63], v[112:115], v[84:87], v[48:63]
    ds_read_b64_tr_b16 v[112:113], v148 offset:3200
    ds_read_b64_tr_b16 v[114:115], v148 offset:3968
    ds_read_b128 v[84:87], v141 offset:0
    s_sub_u32 s47, s47, 1
    s_cmp_lg_u32 s47, 0
    s_cbranch_scc1 C2_L
    s_branch C2_EPI
C2_L_D:
    s_waitcnt vmcnt(0)
    s_branch C2_L_DR
C2_EPI:
    s_mov_b32 m0, s74
    s_nop 0
    buffer_load_dwordx4 v149, s[28:31], s72 offen lds
    s_add_u32 m0, s74, 4032
    s_nop 0
    buffer_load_dwordx4 v149, s[28:31], s72 offen offset:64 lds
    s_add_u32 m0, s74, 8192
    s_nop 0
    buffer_load_dwordx4 v150, s[68:71], s73 offen lds
    v_lshlrev_b32 v11, 2, v1
    s_mul_i32 s40, s63, 2560
    s_add_u32 s40, s40, 19587072
    buffer_load_dword v120, v11, s[24:27], s40 offen offset:0 sc1
    buffer_load_dword v121, v11, s[24:27], s40 offen offset:128 sc1
    buffer_load_dword v122, v11, s[24:27], s40 offen offset:256 sc1
    buffer_load_dword v123, v11, s[24:27], s40 offen offset:384 sc1
    buffer_load_dword v124, v11, s[24:27], s40 offen offset:512 sc1
    buffer_load_dword v125, v11, s[24:27], s40 offen offset:640 sc1
    buffer_load_dword v126, v11, s[24:27], s40 offen offset:768 sc1
    buffer_load_dword v127, v11, s[24:27], s40 offen offset:896 sc1
    buffer_load_dword v128, v11, s[24:27], s40 offen offset:1024 sc1
    buffer_load_dword v129, v11, s[24:27], s40 offen offset:1152 sc1
    buffer_load_dword v130, v11, s[24:27], s40 offen offset:1280 sc1
    buffer_load_dword v131, v11, s[24:27], s40 offen offset:1408 sc1
    buffer_load_dword v132, v11, s[24:27], s40 offen offset:1536 sc1
    buffer_load_dword v133, v11, s[24:27], s40 offen offset:1664 sc1
    buffer_load_dword v134, v11, s[24:27], s40 offen offset:1792 sc1
    v_mov_b32 v1, v10
    s_lshl_b32 s41, s61, 10
    s_add_u32 s41, s41, 53248
    s_mov_b32 s49, 27
    s_waitcnt lgkmcnt(0)
    s_barrier
    s_setprio 3
G_BL:
    s_mov_b32 m0, s41
    s_add_u32 s42, s41, s60
    s_sub_u32 s43, s42, 163840
    s_cmp_ge_u32 s42, 163840
    s_cselect_b32 s42, s43, s42
    s_add_u32 s42, s42, s38
    buffer_load_dwordx4 v1, s[24:27], s42 offen sc1 lds
    s_add_u32 s41, s41, 4096
    s_sub_u32 s49, s49, 1
    s_cmp_lg_u32 s49, 0
    s_cbranch_scc1 G_BL
    s_waitcnt vmcnt(27)
    ds_read_b64_tr_b16 v[96:97], v151 offset:0
    ds_read_b64_tr_b16 v[98:99], v151 offset:256
    ds_read_b64_tr_b16 v[100:101], v151 offset:4096
    ds_read_b64_tr_b16 v[102:103], v151 offset:4352
    ds_read_b64_tr_b16 v[104:105], v151 offset:8192
    ds_read_b64_tr_b16 v[106:107], v151 offset:8448
    s_waitcnt lgkmcnt(0)
    s_mov_b32 s41, s74
    s_mov_b32 m0, s41
    s_add_u32 s42, s41, s60
    s_sub_u32 s43, s42, 163840
    s_cmp_ge_u32 s42, 163840
    s_cselect_b32 s42, s43, s42
    s_add_u32 s42, s42, s38
    buffer_load_dwordx4 v1, s[24:27], s42 offen sc1 lds
    s_add_u32 s41, s41, 4096
    s_mov_b32 m0, s41
    s_add_u32 s42, s41, s60
    s_sub_u32 s43, s42, 163840
    s_cmp_ge_u32 s42, 163840
    s_cselect_b32 s42, s43, s42
    s_add_u32 s42, s42, s38
    buffer_load_dwordx4 v1, s[24:27], s42 offen sc1 lds
    s_add_u32 s41, s41, 4096
    s_mov_b32 m0, s41
    s_add_u32 s42, s41, s60
    s_sub_u32 s43, s42, 163840
    s_cmp_ge_u32 s42, 163840
    s_cselect_b32 s42, s43, s42
    s_add_u32 s42, s42, s38
    buffer_load_dwordx4 v1, s[24:27], s42 offen sc1 lds
    s_add_u32 s41, s41, 4096
    s_mul_i32 s50, s48, 98304
    s_mul_i32 s40, s63, 6144
    s_add_u32 s50, s50, s40
    s_add_u32 s50, s50, 7864320
    v_add_f32 v120, v120, v121
    v_add_f32 v120, v120, v122
    v_add_f32 v120, v120, v123
    v_add_f32 v120, v120, v124
    v_cvt_pk_bf16_f32 v80, v120, v120
    v_and_b32 v81, 0xffff0000, v80
    v_sub_f32 v81, v120, v81
    v_cvt_pk_bf16_f32 v82, v120, v81
    v_and_b32 v80, 0xffff0000, v82
    v_sub_f32 v81, v81, v80
    v_cvt_pk_bf16_f32 v83, v81, 0
    s_nop 1
    v_mfma_f32_32x32x8bf16_1k v[16:31], v[82:83], v[14:15], v[16:31]
    v_add_f32 v125, v125, v126
    v_add_f32 v125, v125, v127
    v_add_f32 v125, v125, v128
    v_add_f32 v125, v125, v129
    v_cvt_pk_bf16_f32 v84, v125, v125
    v_and_b32 v85, 0xffff0000, v84
    v_sub_f32 v85, v125, v85
    v_cvt_pk_bf16_f32 v86, v125, v85
    v_and_b32 v84, 0xffff0000, v86
    v_sub_f32 v85, v85, v84
    v_cvt_pk_bf16_f32 v87, v85, 0
    s_nop 1
    v_mfma_f32_32x32x8bf16_1k v[32:47], v[86:87], v[14:15], v[32:47]
    v_add_f32 v130, v130, v131
    v_add_f32 v130, v130, v132
    v_add_f32 v130, v130, v133
    v_add_f32 v130, v130, v134
    v_cvt_pk_bf16_f32 v88, v130, v130
    v_and_b32 v89, 0xffff0000, v88
    v_sub_f32 v89, v130, v89
    v_cvt_pk_bf16_f32 v90, v130, v89
    v_and_b32 v88, 0xffff0000, v90
    v_sub_f32 v89, v89, v88
    v_cvt_pk_bf16_f32 v91, v89, 0
    s_nop 1
    v_mfma_f32_32x32x8bf16_1k v[48:63], v[90:91], v[14:15], v[48:63]
    v_mul_f32 v16, v12, v16
    v_mul_f32 v17, v12, v17
    v_mul_f32 v18, v12, v18
    v_mul_f32 v19, v12, v19
    v_mul_f32 v20, v12, v20
    v_mul_f32 v21, v12, v21
    v_mul_f32 v22, v12, v22
    v_mul_f32 v23, v12, v23
    v_cvt_pk_bf16_f32 v16, v16, v17
    v_cvt_pk_bf16_f32 v17, v18, v19
    v_cvt_pk_bf16_f32 v18, v20, v21
    v_cvt_pk_bf16_f32 v19, v22, v23
    v_pk_max_i16 v16, v16, 0
    v_pk_max_i16 v17, v17, 0
    v_pk_max_i16 v18, v18, 0
    v_pk_max_i16 v19, v19, 0
    s_waitcnt vmcnt(0)
    buffer_store_dwordx4 v[16:19], v10, s[24:27], s50 offen offset:0 sc1
    v_mul_f32 v24, v12, v24
    v_mul_f32 v25, v12, v25
    v_mul_f32 v26, v12, v26
    v_mul_f32 v27, v12, v27
    v_mul_f32 v28, v12, v28
    v_mul_f32 v29, v12, v29
    v_mul_f32 v30, v12, v30
    v_mul_f32 v31, v12, v31
    v_cvt_pk_bf16_f32 v24, v24, v25
    v_cvt_pk_bf16_f32 v25, v26, v27
    v_cvt_pk_bf16_f32 v26, v28, v29
    v_cvt_pk_bf16_f32 v27, v30, v31
    v_pk_max_i16 v24, v24, 0
    v_pk_max_i16 v25, v25, 0
    v_pk_max_i16 v26, v26, 0
    v_pk_max_i16 v27, v27, 0
    buffer_store_dwordx4 v[24:27], v10, s[24:27], s50 offen offset:1024 sc1
    s_add_u32 s50, s50, 2048
    v_mul_f32 v32, v12, v32
    v_mul_f32 v33, v12, v33
    v_mul_f32 v34, v12, v34
    v_mul_f32 v35, v12, v35
    v_mul_f32 v36, v12, v36
    v_mul_f32 v37, v12, v37
    v_mul_f32 v38, v12, v38
    v_mul_f32 v39, v12, v39
    v_cvt_pk_bf16_f32 v32, v32, v33
    v_cvt_pk_bf16_f32 v33, v34, v35
    v_cvt_pk_bf16_f32 v34, v36, v37
    v_cvt_pk_bf16_f32 v35, v38, v39
    v_pk_max_i16 v32, v32, 0
    v_pk_max_i16 v33, v33, 0
    v_pk_max_i16 v34, v34, 0
    v_pk_max_i16 v35, v35, 0
    buffer_store_dwordx4 v[32:35], v10, s[24:27], s50 offen offset:0 sc1
    v_mul_f32 v40, v12, v40
    v_mul_f32 v41, v12, v41
    v_mul_f32 v42, v12, v42
    v_mul_f32 v43, v12, v43
    v_mul_f32 v44, v12, v44
    v_mul_f32 v45, v12, v45
    v_mul_f32 v46, v12, v46
    v_mul_f32 v47, v12, v47
    v_cvt_pk_bf16_f32 v40, v40, v41
    v_cvt_pk_bf16_f32 v41, v42, v43
    v_cvt_pk_bf16_f32 v42, v44, v45
    v_cvt_pk_bf16_f32 v43, v46, v47
    v_pk_max_i16 v40, v40, 0
    v_pk_max_i16 v41, v41, 0
    v_pk_max_i16 v42, v42, 0
    v_pk_max_i16 v43, v43, 0
    buffer_store_dwordx4 v[40:43], v10, s[24:27], s50 offen offset:1024 sc1
    s_add_u32 s50, s50, 2048
    v_mul_f32 v48, v12, v48
    v_mul_f32 v49, v12, v49
    v_mul_f32 v50, v12, v50
    v_mul_f32 v51, v12, v51
    v_mul_f32 v52, v12, v52
    v_mul_f32 v53, v12, v53
    v_mul_f32 v54, v12, v54
    v_mul_f32 v55, v12, v55
    v_cvt_pk_bf16_f32 v48, v48, v49
    v_cvt_pk_bf16_f32 v49, v50, v51
    v_cvt_pk_bf16_f32 v50, v52, v53
    v_cvt_pk_bf16_f32 v51, v54, v55
    v_pk_max_i16 v48, v48, 0
    v_pk_max_i16 v49, v49, 0
    v_pk_max_i16 v50, v50, 0
    v_pk_max_i16 v51, v51, 0
    buffer_store_dwordx4 v[48:51], v10, s[24:27], s50 offen offset:0 sc1
    v_mul_f32 v56, v12, v56
    v_mul_f32 v57, v12, v57
    v_mul_f32 v58, v12, v58
    v_mul_f32 v59, v12, v59
    v_mul_f32 v60, v12, v60
    v_mul_f32 v61, v12, v61
    v_mul_f32 v62, v12, v62
    v_mul_f32 v63, v12, v63
    v_cvt_pk_bf16_f32 v56, v56, v57
    v_cvt_pk_bf16_f32 v57, v58, v59
    v_cvt_pk_bf16_f32 v58, v60, v61
    v_cvt_pk_bf16_f32 v59, v62, v63
    v_pk_max_i16 v56, v56, 0
    v_pk_max_i16 v57, v57, 0
    v_pk_max_i16 v58, v58, 0
    v_pk_max_i16 v59, v59, 0
    buffer_store_dwordx4 v[56:59], v10, s[24:27], s50 offen offset:1024 sc1
    s_add_u32 s50, s50, 2048
    s_lshl_b32 s40, s58, 11
    s_add_u32 s40, s40, 14155776
    s_lshl_b32 s41, s58, 10
    s_add_u32 s41, s41, 16121856
    s_cmp_ge_u32 s58, 960
    s_cbranch_scc1 G_RL
    buffer_store_dwordx4 v[96:99], v10, s[24:27], s40 offen sc1
    buffer_store_dwordx4 v[100:103], v10, s[24:27], s40 offen offset:1024 sc1
    s_cmp_ge_u32 s58, 800
    s_cbranch_scc1 G_RL
    buffer_store_dwordx4 v[104:107], v10, s[24:27], s41 offen sc1
G_RL:
    v_mov_b32 v108, -1
    v_mov_b32 v109, -1
    v_mov_b32 v110, -1
    v_mov_b32 v111, -1
    s_mul_i32 s40, s58, 2560
    s_add_u32 s40, s40, 16941056
    buffer_store_dwordx4 v[108:111], v10, s[24:27], s40 offen offset:0 sc1
    buffer_store_dwordx4 v[108:111], v10, s[24:27], s40 offen offset:1024 sc1
    buffer_store_dwordx4 v[108:111], v10, s[24:27], s40 offen offset:1536 sc1
    s_bfe_u32 s40, s33, 0x10002
    s_mul_i32 s40, s40, 3072
    v_add_u32 v2, s40, v1
    s_mul_i32 s40, s61, 24576
    s_add_u32 s40, s40, 7864320
    s_mul_i32 s46, s33, 98304
    s_add_u32 s46, s46, s40
    s_xor_b32 s45, s33, 4
    s_mul_i32 s45, s45, 98304
    s_add_u32 s45, s45, s40
    s_mul_i32 s47, s61, 491520
    s_mul_i32 s40, s34, 5120
    s_add_u32 s47, s47, s40
    s_add_u32 s47, s47, 14155776
    v_mov_b32 v3, v152
    v_mov_b32 v4, v153
    v_mov_b32 v5, v154
    v_mov_b32 v6, v155
    v_mov_b32 v14, 0
    v_mov_b32 v15, 0
    ds_write_b64 v14, v[14:15]
    s_waitcnt lgkmcnt(0)
    s_barrier
    v_mov_b32 v15, 1
    s_lshl_b32 s40, s48, 7
    s_add_u32 s40, s40, 19578880
    v_lshlrev_b32 v112, 11, v0
    v_mov_b32 v113, 0x10000
    s_lshl_b32 s41, s63, 7
    s_add_u32 s41, s41, 19562496
    s_waitcnt vmcnt(0)
    s_mov_b64 exec, 1
    ds_add_rtn_u32 v13, v14, v15 offset:4
    buffer_atomic_add v15, v14, s[24:27], s40 offen sc1
    s_waitcnt lgkmcnt(0)
    v_cmp_eq_u32 vcc, 3, v13
    s_mov_b64 exec, 0xff
    s_cbranch_vccz G_S2
    buffer_atomic_add v113, v112, s[24:27], s41 offen sc1
G_S2:
    s_mov_b64 exec, -1
    s_mov_b32 s40, 19562496
    s_lshl_b32 s41, s3, 11
    v_lshl_add_u32 v96, v0, 7, s41
    s_lshl_b32 s41, s33, 7
    s_add_u32 s41, s41, 16384
    v_writelane_b32 v96, s41, 16
    s_xor_b32 s41, s41, 512
    v_writelane_b32 v96, s41, 17
    v_mov_b32 v97, 0x100010
    v_writelane_b32 v97, 16, 16
    v_writelane_b32 v97, 16, 17
    s_mov_b64 exec, 0x3ffff
    s_mov_b32 s49, 200000
G_P1:
    s_sleep 12
    buffer_load_dword v15, v96, s[24:27], s40 offen sc1
    s_sub_u32 s49, s49, 1
    s_waitcnt vmcnt(0)
    v_cmp_ne_u32 vcc, v97, v15
    s_cmp_eq_u32 s49, 0
    s_cbranch_scc1 G_P1X
    s_cbranch_vccnz G_P1
G_P1X:
    s_mov_b64 exec, -1
    s_setprio 0
    buffer_load_dwordx4 v[112:115], v1, s[24:27], s47 offen offset:2048 sc1
    buffer_load_dwordx4 v[104:107], v2, s[24:27], s47 offen offset:0 sc1
    buffer_load_dwordx4 v[96:99], v1, s[24:27], s46 offen sc1
    buffer_load_dwordx4 v[100:103], v1, s[24:27], s45 offen sc1
    buffer_load_dwordx4 v[108:111], v2, s[24:27], s47 offen offset:1024 sc1
    s_add_u32 s46, s46, 1024
    s_add_u32 s45, s45, 1024
    s_add_u32 s47, s47, 20480
    buffer_load_dwordx4 v[132:135], v1, s[24:27], s47 offen offset:2048 sc1
    buffer_load_dwordx4 v[124:127], v2, s[24:27], s47 offen offset:0 sc1
    buffer_load_dwordx4 v[116:119], v1, s[24:27], s46 offen sc1
    buffer_load_dwordx4 v[120:123], v1, s[24:27], s45 offen sc1
    buffer_load_dwordx4 v[128:131], v2, s[24:27], s47 offen offset:1024 sc1
    s_add_u32 s46, s46, 1024
    s_add_u32 s45, s45, 1024
    s_add_u32 s47, s47, 20480
    buffer_load_dwordx4 v[152:155], v1, s[24:27], s47 offen offset:2048 sc1
    buffer_load_dwordx4 v[144:147], v2, s[24:27], s47 offen offset:0 sc1
    buffer_load_dwordx4 v[136:139], v1, s[24:27], s46 offen sc1
    buffer_load_dwordx4 v[140:143], v1, s[24:27], s45 offen sc1
    buffer_load_dwordx4 v[148:151], v2, s[24:27], s47 offen offset:1024 sc1
    s_add_u32 s46, s46, 1024
    s_add_u32 s45, s45, 1024
    s_add_u32 s47, s47, 20480
    s_mov_b32 s49, 7
    s_waitcnt vmcnt(10)
    v_mfma_f32_32x32x16_bf16 v[48:63], v[112:115], v[96:99], 0
    buffer_load_dwordx4 v[112:115], v1, s[24:27], s47 offen offset:2048 sc1
    v_mfma_f32_32x32x16_bf16 v[16:31], v[104:107], v[96:99], 0
    v_mfma_f32_32x32x16_bf16 v[64:79], v[104:107], v[100:103], 0
    buffer_load_dwordx4 v[104:107], v2, s[24:27], s47 offen offset:0 sc1
    v_mfma_f32_32x32x16_bf16 v[32:47], v[108:111], v[96:99], 0
    buffer_load_dwordx4 v[96:99], v1, s[24:27], s46 offen sc1
    v_mfma_f32_32x32x16_bf16 v[80:95], v[108:111], v[100:103], 0
    buffer_load_dwordx4 v[100:103], v1, s[24:27], s45 offen sc1
    buffer_load_dwordx4 v[108:111], v2, s[24:27], s47 offen offset:1024 sc1
    s_add_u32 s46, s46, 1024
    s_add_u32 s45, s45, 1024
    s_add_u32 s47, s47, 20480
    s_branch G_L1
G_L:
    s_waitcnt vmcnt(10)
    v_mfma_f32_32x32x16_bf16 v[48:63], v[112:115], v[96:99], v[48:63]
    buffer_load_dwordx4 v[112:115], v1, s[24:27], s47 offen offset:2048 sc1
    v_mfma_f32_32x32x16_bf16 v[16:31], v[104:107], v[96:99], v[16:31]
    v_mfma_f32_32x32x16_bf16 v[64:79], v[104:107], v[100:103], v[64:79]
    buffer_load_dwordx4 v[104:107], v2, s[24:27], s47 offen offset:0 sc1
    v_mfma_f32_32x32x16_bf16 v[32:47], v[108:111], v[96:99], v[32:47]
    buffer_load_dwordx4 v[96:99], v1, s[24:27], s46 offen sc1
    v_mfma_f32_32x32x16_bf16 v[80:95], v[108:111], v[100:103], v[80:95]
    buffer_load_dwordx4 v[100:103], v1, s[24:27], s45 offen sc1
    buffer_load_dwordx4 v[108:111], v2, s[24:27], s47 offen offset:1024 sc1
    s_add_u32 s46, s46, 1024
    s_add_u32 s45, s45, 1024
    s_add_u32 s47, s47, 20480
G_L1:
    s_waitcnt vmcnt(10)
    v_mfma_f32_32x32x16_bf16 v[48:63], v[132:135], v[116:119], v[48:63]
    buffer_load_dwordx4 v[132:135], v1, s[24:27], s47 offen offset:2048 sc1
    v_mfma_f32_32x32x16_bf16 v[16:31], v[124:127], v[116:119], v[16:31]
    v_mfma_f32_32x32x16_bf16 v[64:79], v[124:127], v[120:123], v[64:79]
    buffer_load_dwordx4 v[124:127], v2, s[24:27], s47 offen offset:0 sc1
    v_mfma_f32_32x32x16_bf16 v[32:47], v[128:131], v[116:119], v[32:47]
    buffer_load_dwordx4 v[116:119], v1, s[24:27], s46 offen sc1
    v_mfma_f32_32x32x16_bf16 v[80:95], v[128:131], v[120:123], v[80:95]
    buffer_load_dwordx4 v[120:123], v1, s[24:27], s45 offen sc1
    buffer_load_dwordx4 v[128:131], v2, s[24:27], s47 offen offset:1024 sc1
    s_add_u32 s46, s46, 1024
    s_add_u32 s45, s45, 1024
    s_add_u32 s47, s47, 20480
    s_waitcnt vmcnt(10)
    v_mfma_f32_32x32x16_bf16 v[48:63], v[152:155], v[136:139], v[48:63]
    buffer_load_dwordx4 v[152:155], v1, s[24:27], s47 offen offset:2048 sc1
    v_mfma_f32_32x32x16_bf16 v[16:31], v[144:147], v[136:139], v[16:31]
    v_mfma_f32_32x32x16_bf16 v[64:79], v[144:147], v[140:143], v[64:79]
    buffer_load_dwordx4 v[144:147], v2, s[24:27], s47 offen offset:0 sc1
    v_mfma_f32_32x32x16_bf16 v[32:47], v[148:151], v[136:139], v[32:47]
    buffer_load_dwordx4 v[136:139], v1, s[24:27], s46 offen sc1
    v_mfma_f32_32x32x16_bf16 v[80:95], v[148:151], v[140:143], v[80:95]
    buffer_load_dwordx4 v[140:143], v1, s[24:27], s45 offen sc1
    buffer_load_dwordx4 v[148:151], v2, s[24:27], s47 offen offset:1024 sc1
    s_add_u32 s46, s46, 1024
    s_add_u32 s45, s45, 1024
    s_add_u32 s47, s47, 20480
    s_sub_u32 s49, s49, 1
    s_cmp_lg_u32 s49, 0
    s_cbranch_scc1 G_L
    s_waitcnt vmcnt(10)
    v_mfma_f32_32x32x16_bf16 v[48:63], v[112:115], v[96:99], v[48:63]
    v_mfma_f32_32x32x16_bf16 v[16:31], v[104:107], v[96:99], v[16:31]
    v_mfma_f32_32x32x16_bf16 v[64:79], v[104:107], v[100:103], v[64:79]
    v_mfma_f32_32x32x16_bf16 v[32:47], v[108:111], v[96:99], v[32:47]
    v_mfma_f32_32x32x16_bf16 v[80:95], v[108:111], v[100:103], v[80:95]
    s_waitcnt vmcnt(5)
    v_mfma_f32_32x32x16_bf16 v[48:63], v[132:135], v[116:119], v[48:63]
    v_mfma_f32_32x32x16_bf16 v[16:31], v[124:127], v[116:119], v[16:31]
    v_mfma_f32_32x32x16_bf16 v[64:79], v[124:127], v[120:123], v[64:79]
    v_mfma_f32_32x32x16_bf16 v[32:47], v[128:131], v[116:119], v[32:47]
    v_mfma_f32_32x32x16_bf16 v[80:95], v[128:131], v[120:123], v[80:95]
    s_waitcnt vmcnt(0)
    v_mfma_f32_32x32x16_bf16 v[48:63], v[152:155], v[136:139], v[48:63]
    v_mfma_f32_32x32x16_bf16 v[16:31], v[144:147], v[136:139], v[16:31]
    v_mfma_f32_32x32x16_bf16 v[64:79], v[144:147], v[140:143], v[64:79]
    v_mfma_f32_32x32x16_bf16 v[32:47], v[148:151], v[136:139], v[32:47]
    v_mfma_f32_32x32x16_bf16 v[80:95], v[148:151], v[140:143], v[80:95]
    s_setprio 3
    s_and_b32 s41, s33, 15
    s_lshl_b32 s41, s41, 2
    s_add_u32 s41, s41, s61
    s_min_u32 s41, s41, 39
    s_mul_i32 s41, s41, 20480
    s_mul_i32 s43, s34, 5120
    s_add_u32 s41, s41, s43
    s_add_u32 s41, s41, 16121856
    s_add_u32 s42, s41, 4096
    buffer_load_dwordx4 v[156:159], v1, s[24:27], s41 offen offset:0 sc1
    buffer_load_dwordx4 v[156:159], v1, s[24:27], s41 offen offset:1024 sc1
    buffer_load_dwordx4 v[156:159], v1, s[24:27], s41 offen offset:2048 sc1
    buffer_load_dwordx4 v[156:159], v1, s[24:27], s41 offen offset:3072 sc1
    buffer_load_dwordx4 v[156:159], v1, s[24:27], s42 offen sc1
    s_lshl_b32 s50, s35, 6
    s_sub_u32 s50, s50, 128
    v_add_u32 v160, s50, v0
    s_movk_i32 s51, 3277
    v_mul_u32_u24 v161, s51, v160
    v_lshrrev_b32 v161, 16, v161
    v_lshlrev_b32 v164, 4, v161
    v_lshl_add_u32 v164, v160, 5, v164
    v_add_u32 v164, 2560, v164
    v_mul_u32_u24 v165, 1280, v161
    v_mul_u32_u24 v161, 20, v161
    v_sub_u32 v160, v160, v161
    v_and_b32 v161, 3, v160
    v_lshl_add_u32 v165, v161, 4, v165
    v_lshrrev_b32 v160, 2, v160
    s_bfe_u32 s50, s33, 0x10002
    s_mul_i32 s51, s50, 3
    s_mul_i32 s52, s50, 163840
    s_sub_u32 s53, 163648, s52
    v_cmp_eq_u32 vcc, 2, v160
    v_add_u32 v161, s51, v160
    v_mov_b32 v162, s52
    v_cndmask_b32 v161, v161, v160, vcc
    v_cmp_le_u32 vcc, 3, v160
    v_mov_b32 v163, s53
    v_lshl_add_u32 v165, v161, 6, v165
    v_cndmask_b32 v162, v162, v163, vcc
    s_andn2_b32 s54, s33, 4
    v_add_u32 v165, v165, v162
    s_mul_i32 s54, s54, 40960
    s_mul_i32 s51, s34, 320
    s_add_u32 s54, s54, s51
    buffer_load_dwordx4 v[160:163], v165, s[16:19], s54 offen
    v_mov_b32 v14, 0
    v_mov_b32 v15, 1
    v_xor_b32 v9, 32, v3
    v_xor_b32 v10, 64, v3
    v_xor_b32 v11, 96, v3
    ds_write_b128 v3, v[16:19] offset:0
    ds_write_b128 v9, v[20:23] offset:0
    ds_write_b128 v10, v[24:27] offset:0
    ds_write_b128 v11, v[28:31] offset:0
    s_waitcnt lgkmcnt(0)
    s_mov_b64 exec, 1
    ds_add_u32 v14, v15
    s_mov_b64 exec, -1
    s_mov_b32 s49, 2000000
G_Y1:
    ds_read_b32 v13, v14
    s_sub_u32 s49, s49, 1
    s_waitcnt lgkmcnt(0)
    v_cmp_gt_u32 vcc, 4, v13
    s_cbranch_vccz G_Y1X
    s_sleep 6
    s_cmp_lg_u32 s49, 0
    s_cbranch_scc1 G_Y1
G_Y1X:
    ds_read_b128 v[16:19], v4 offset:0
    ds_read_b128 v[20:23], v4 offset:4096
    ds_read_b128 v[24:27], v4 offset:8192
    ds_read_b128 v[28:31], v4 offset:12288
    ds_write_b128 v3, v[32:35] offset:16384
    ds_write_b128 v9, v[36:39] offset:16384
    ds_write_b128 v10, v[40:43] offset:16384
    ds_write_b128 v11, v[44:47] offset:16384
    s_waitcnt lgkmcnt(0)
    s_mov_b64 exec, 1
    ds_add_u32 v14, v15
    s_mov_b64 exec, -1
    s_mov_b32 s49, 2000000
G_Y2:
    ds_read_b32 v13, v14
    s_sub_u32 s49, s49, 1
    s_waitcnt lgkmcnt(0)
    v_cmp_gt_u32 vcc, 8, v13
    s_cbranch_vccz G_Y2X
    s_sleep 6
    s_cmp_lg_u32 s49, 0
    s_cbranch_scc1 G_Y2
G_Y2X:
    ds_read_b128 v[32:35], v4 offset:16384
    ds_read_b128 v[36:39], v4 offset:20480
    ds_read_b128 v[40:43], v4 offset:24576
    ds_read_b128 v[44:47], v4 offset:28672
    ds_write_b128 v3, v[48:51] offset:0
    ds_write_b128 v9, v[52:55] offset:0
    ds_write_b128 v10, v[56:59] offset:0
    ds_write_b128 v11, v[60:63] offset:0
    s_waitcnt lgkmcnt(0)
    s_mov_b64 exec, 1
    ds_add_u32 v14, v15
    s_mov_b64 exec, -1
    s_mov_b32 s49, 2000000
G_Y3:
    ds_read_b32 v13, v14
    s_sub_u32 s49, s49, 1
    s_waitcnt lgkmcnt(0)
    v_cmp_gt_u32 vcc, 12, v13
    s_cbranch_vccz G_Y3X
    s_sleep 6
    s_cmp_lg_u32 s49, 0
    s_cbranch_scc1 G_Y3
G_Y3X:
    ds_read_b128 v[48:51], v4 offset:0
    ds_read_b128 v[52:55], v4 offset:4096
    ds_read_b128 v[56:59], v4 offset:8192
    ds_read_b128 v[60:63], v4 offset:12288
    ds_write_b128 v3, v[64:67] offset:16384
    ds_write_b128 v9, v[68:71] offset:16384
    ds_write_b128 v10, v[72:75] offset:16384
    ds_write_b128 v11, v[76:79] offset:16384
    s_waitcnt lgkmcnt(0)
    s_mov_b64 exec, 1
    ds_add_u32 v14, v15
    s_mov_b64 exec, -1
    s_mov_b32 s49, 2000000
G_Y4:
    ds_read_b32 v13, v14
    s_sub_u32 s49, s49, 1
    s_waitcnt lgkmcnt(0)
    v_cmp_gt_u32 vcc, 16, v13
    s_cbranch_vccz G_Y4X
    s_sleep 6
    s_cmp_lg_u32 s49, 0
    s_cbranch_scc1 G_Y4
G_Y4X:
    ds_read_b128 v[64:67], v4 offset:16384
    ds_read_b128 v[68:71], v4 offset:20480
    ds_read_b128 v[72:75], v4 offset:24576
    ds_read_b128 v[76:79], v4 offset:28672
    ds_write_b128 v3, v[80:83] offset:0
    ds_write_b128 v9, v[84:87] offset:0
    ds_write_b128 v10, v[88:91] offset:0
    ds_write_b128 v11, v[92:95] offset:0
    s_waitcnt lgkmcnt(0)
    s_mov_b64 exec, 1
    ds_add_u32 v14, v15
    s_mov_b64 exec, -1
    s_mov_b32 s49, 2000000
G_Y5:
    ds_read_b32 v13, v14
    s_sub_u32 s49, s49, 1
    s_waitcnt lgkmcnt(0)
    v_cmp_gt_u32 vcc, 20, v13
    s_cbranch_vccz G_Y5X
    s_sleep 6
    s_cmp_lg_u32 s49, 0
    s_cbranch_scc1 G_Y5
G_Y5X:
    ds_read_b128 v[80:83], v4 offset:0
    ds_read_b128 v[84:87], v4 offset:4096
    ds_read_b128 v[88:91], v4 offset:8192
    ds_read_b128 v[92:95], v4 offset:12288
    s_waitcnt lgkmcnt(0)
    s_mov_b64 exec, 1
    ds_add_u32 v14, v15
    s_mov_b64 exec, -1
    s_mov_b32 s49, 2000000
G_Y6:
    ds_read_b32 v13, v14
    s_sub_u32 s49, s49, 1
    s_waitcnt lgkmcnt(0)
    v_cmp_gt_u32 vcc, 24, v13
    s_cbranch_vccz G_Y6X
    s_sleep 6
    s_cmp_lg_u32 s49, 0
    s_cbranch_scc1 G_Y6
G_Y6X:
    s_setprio 0
    v_pk_add_f32 v[16:17], v[16:17], v[20:21]
    v_pk_add_f32 v[24:25], v[24:25], v[28:29]
    v_pk_add_f32 v[18:19], v[18:19], v[22:23]
    v_pk_add_f32 v[26:27], v[26:27], v[30:31]
    v_pk_add_f32 v[16:17], v[16:17], v[24:25]
    v_pk_add_f32 v[18:19], v[18:19], v[26:27]
    v_cvt_pk_bf16_f32 v20, v16, v17
    v_cvt_pk_bf16_f32 v21, v18, v19
    v_lshlrev_b32 v16, 16, v20
    v_and_b32 v17, 0xffff0000, v20
    v_lshlrev_b32 v18, 16, v21
    v_and_b32 v19, 0xffff0000, v21
    v_mul_f32 v20, 0xbfb8aa3b, v16
    v_mul_f32 v21, 0xbfb8aa3b, v17
    v_mul_f32 v22, 0xbfb8aa3b, v18
    v_mul_f32 v23, 0xbfb8aa3b, v19
    v_exp_f32 v20, v20
    v_exp_f32 v21, v21
    v_exp_f32 v22, v22
    v_exp_f32 v23, v23
    v_add_f32 v20, 1.0, v20
    v_add_f32 v21, 1.0, v21
    v_add_f32 v22, 1.0, v22
    v_add_f32 v23, 1.0, v23
    v_rcp_f32 v20, v20
    v_rcp_f32 v21, v21
    v_rcp_f32 v22, v22
    v_rcp_f32 v23, v23
    v_mul_f32 v16, v16, v20
    v_mul_f32 v17, v17, v21
    v_mul_f32 v18, v18, v22
    v_mul_f32 v19, v19, v23
    v_cvt_pk_bf16_f32 v20, v16, v17
    v_cvt_pk_bf16_f32 v21, v18, v19
    v_lshlrev_b32 v16, 16, v20
    v_and_b32 v17, 0xffff0000, v20
    v_lshlrev_b32 v18, 16, v21
    v_and_b32 v19, 0xffff0000, v21
    ds_write_b128 v5, v[16:19] offset:0
    v_pk_add_f32 v[32:33], v[32:33], v[36:37]
    v_pk_add_f32 v[40:41], v[40:41], v[44:45]
    v_pk_add_f32 v[34:35], v[34:35], v[38:39]
    v_pk_add_f32 v[42:43], v[42:43], v[46:47]
    v_pk_add_f32 v[32:33], v[32:33], v[40:41]
    v_pk_add_f32 v[34:35], v[34:35], v[42:43]
    v_cvt_pk_bf16_f32 v36, v32, v33
    v_cvt_pk_bf16_f32 v37, v34, v35
    v_lshlrev_b32 v32, 16, v36
    v_and_b32 v33, 0xffff0000, v36
    v_lshlrev_b32 v34, 16, v37
    v_and_b32 v35, 0xffff0000, v37
    v_mul_f32 v36, 0xbfb8aa3b, v32
    v_mul_f32 v37, 0xbfb8aa3b, v33
    v_mul_f32 v38, 0xbfb8aa3b, v34
    v_mul_f32 v39, 0xbfb8aa3b, v35
    v_exp_f32 v36, v36
    v_exp_f32 v37, v37
    v_exp_f32 v38, v38
    v_exp_f32 v39, v39
    v_add_f32 v36, 1.0, v36
    v_add_f32 v37, 1.0, v37
    v_add_f32 v38, 1.0, v38
    v_add_f32 v39, 1.0, v39
    v_rcp_f32 v36, v36
    v_rcp_f32 v37, v37
    v_rcp_f32 v38, v38
    v_rcp_f32 v39, v39
    v_mul_f32 v32, v32, v36
    v_mul_f32 v33, v33, v37
    v_mul_f32 v34, v34, v38
    v_mul_f32 v35, v35, v39
    v_cvt_pk_bf16_f32 v36, v32, v33
    v_cvt_pk_bf16_f32 v37, v34, v35
    v_lshlrev_b32 v32, 16, v36
    v_and_b32 v33, 0xffff0000, v36
    v_lshlrev_b32 v34, 16, v37
    v_and_b32 v35, 0xffff0000, v37
    ds_write_b128 v5, v[32:35] offset:128
    v_pk_add_f32 v[48:49], v[48:49], v[52:53]
    v_pk_add_f32 v[56:57], v[56:57], v[60:61]
    v_pk_add_f32 v[50:51], v[50:51], v[54:55]
    v_pk_add_f32 v[58:59], v[58:59], v[62:63]
    v_pk_add_f32 v[48:49], v[48:49], v[56:57]
    v_pk_add_f32 v[50:51], v[50:51], v[58:59]
    v_cvt_pk_bf16_f32 v52, v48, v49
    v_cvt_pk_bf16_f32 v53, v50, v51
    v_lshlrev_b32 v48, 16, v52
    v_and_b32 v49, 0xffff0000, v52
    v_lshlrev_b32 v50, 16, v53
    v_and_b32 v51, 0xffff0000, v53
    v_mul_f32 v52, 0xbfb8aa3b, v48
    v_mul_f32 v53, 0xbfb8aa3b, v49
    v_mul_f32 v54, 0xbfb8aa3b, v50
    v_mul_f32 v55, 0xbfb8aa3b, v51
    v_exp_f32 v52, v52
    v_exp_f32 v53, v53
    v_exp_f32 v54, v54
    v_exp_f32 v55, v55
    v_add_f32 v52, 1.0, v52
    v_add_f32 v53, 1.0, v53
    v_add_f32 v54, 1.0, v54
    v_add_f32 v55, 1.0, v55
    v_rcp_f32 v52, v52
    v_rcp_f32 v53, v53
    v_rcp_f32 v54, v54
    v_rcp_f32 v55, v55
    v_mul_f32 v48, v48, v52
    v_mul_f32 v49, v49, v53
    v_mul_f32 v50, v50, v54
    v_mul_f32 v51, v51, v55
    v_cvt_pk_bf16_f32 v52, v48, v49
    v_cvt_pk_bf16_f32 v53, v50, v51
    v_lshlrev_b32 v48, 16, v52
    v_and_b32 v49, 0xffff0000, v52
    v_lshlrev_b32 v50, 16, v53
    v_and_b32 v51, 0xffff0000, v53
    ds_write_b128 v5, v[48:51] offset:256
    v_pk_add_f32 v[64:65], v[64:65], v[68:69]
    v_pk_add_f32 v[72:73], v[72:73], v[76:77]
    v_pk_add_f32 v[66:67], v[66:67], v[70:71]
    v_pk_add_f32 v[74:75], v[74:75], v[78:79]
    v_pk_add_f32 v[64:65], v[64:65], v[72:73]
    v_pk_add_f32 v[66:67], v[66:67], v[74:75]
    v_cvt_pk_bf16_f32 v68, v64, v65
    v_cvt_pk_bf16_f32 v69, v66, v67
    v_lshlrev_b32 v64, 16, v68
    v_and_b32 v65, 0xffff0000, v68
    v_lshlrev_b32 v66, 16, v69
    v_and_b32 v67, 0xffff0000, v69
    v_mul_f32 v68, 0xbfb8aa3b, v64
    v_mul_f32 v69, 0xbfb8aa3b, v65
    v_mul_f32 v70, 0xbfb8aa3b, v66
    v_mul_f32 v71, 0xbfb8aa3b, v67
    v_exp_f32 v68, v68
    v_exp_f32 v69, v69
    v_exp_f32 v70, v70
    v_exp_f32 v71, v71
    v_add_f32 v68, 1.0, v68
    v_add_f32 v69, 1.0, v69
    v_add_f32 v70, 1.0, v70
    v_add_f32 v71, 1.0, v71
    v_rcp_f32 v68, v68
    v_rcp_f32 v69, v69
    v_rcp_f32 v70, v70
    v_rcp_f32 v71, v71
    v_mul_f32 v64, v64, v68
    v_mul_f32 v65, v65, v69
    v_mul_f32 v66, v66, v70
    v_mul_f32 v67, v67, v71
    v_cvt_pk_bf16_f32 v68, v64, v65
    v_cvt_pk_bf16_f32 v69, v66, v67
    v_lshlrev_b32 v64, 16, v68
    v_and_b32 v65, 0xffff0000, v68
    v_lshlrev_b32 v66, 16, v69
    v_and_b32 v67, 0xffff0000, v69
    ds_write_b128 v5, v[64:67] offset:384
    v_pk_add_f32 v[80:81], v[80:81], v[84:85]
    v_pk_add_f32 v[88:89], v[88:89], v[92:93]
    v_pk_add_f32 v[82:83], v[82:83], v[86:87]
    v_pk_add_f32 v[90:91], v[90:91], v[94:95]
    v_pk_add_f32 v[80:81], v[80:81], v[88:89]
    v_pk_add_f32 v[82:83], v[82:83], v[90:91]
    v_cvt_pk_bf16_f32 v84, v80, v81
    v_cvt_pk_bf16_f32 v85, v82, v83
    v_lshlrev_b32 v80, 16, v84
    v_and_b32 v81, 0xffff0000, v84
    v_lshlrev_b32 v82, 16, v85
    v_and_b32 v83, 0xffff0000, v85
    v_mul_f32 v84, 0xbfb8aa3b, v80
    v_mul_f32 v85, 0xbfb8aa3b, v81
    v_mul_f32 v86, 0xbfb8aa3b, v82
    v_mul_f32 v87, 0xbfb8aa3b, v83
    v_exp_f32 v84, v84
    v_exp_f32 v85, v85
    v_exp_f32 v86, v86
    v_exp_f32 v87, v87
    v_add_f32 v84, 1.0, v84
    v_add_f32 v85, 1.0, v85
    v_add_f32 v86, 1.0, v86
    v_add_f32 v87, 1.0, v87
    v_rcp_f32 v84, v84
    v_rcp_f32 v85, v85
    v_rcp_f32 v86, v86
    v_rcp_f32 v87, v87
    v_mul_f32 v80, v80, v84
    v_mul_f32 v81, v81, v85
    v_mul_f32 v82, v82, v86
    v_mul_f32 v83, v83, v87
    v_cvt_pk_bf16_f32 v84, v80, v81
    v_cvt_pk_bf16_f32 v85, v82, v83
    v_lshlrev_b32 v80, 16, v84
    v_and_b32 v81, 0xffff0000, v84
    v_lshlrev_b32 v82, 16, v85
    v_and_b32 v83, 0xffff0000, v85
    ds_write_b128 v5, v[80:83] offset:512
    s_setprio 3
    s_barrier
M_FINAL:
    v_add_u32 v166, 62976, v164
    s_waitcnt lgkmcnt(0)
    s_barrier
    s_cmp_lt_u32 s35, 2
    s_cbranch_scc1 M_OUT
    ds_read_b128 v[32:35], v164 offset:20992
    ds_read_b128 v[36:39], v164 offset:21008
    ds_read_b128 v[40:43], v164 offset:41984
    ds_read_b128 v[44:47], v164 offset:42000
    ds_read_b128 v[48:51], v164 offset:0
    ds_read_b128 v[52:55], v164 offset:16
    ds_read_b128 v[56:59], v166 offset:0
    ds_read_b128 v[60:63], v166 offset:16
    ds_read_b128 v[64:67], v166 offset:20992
    ds_read_b128 v[68:71], v166 offset:21008
    s_waitcnt vmcnt(0)
    v_lshlrev_b32 v72, 16, v160
    v_and_b32 v73, 0xffff0000, v160
    v_lshlrev_b32 v74, 16, v161
    v_and_b32 v75, 0xffff0000, v161
    v_lshlrev_b32 v76, 16, v162
    v_and_b32 v77, 0xffff0000, v162
    v_lshlrev_b32 v78, 16, v163
    v_and_b32 v79, 0xffff0000, v163
    s_waitcnt lgkmcnt(6)
    v_pk_add_f32 v[32:33], v[32:33], v[40:41]
    v_pk_add_f32 v[34:35], v[34:35], v[42:43]
    v_pk_add_f32 v[36:37], v[36:37], v[44:45]
    v_pk_add_f32 v[38:39], v[38:39], v[46:47]
    s_waitcnt lgkmcnt(0)
    v_pk_add_f32 v[56:57], v[56:57], v[64:65]
    v_pk_add_f32 v[58:59], v[58:59], v[66:67]
    v_pk_add_f32 v[60:61], v[60:61], v[68:69]
    v_pk_add_f32 v[62:63], v[62:63], v[70:71]
    v_pk_add_f32 v[32:33], v[32:33], v[56:57]
    v_pk_add_f32 v[34:35], v[34:35], v[58:59]
    v_pk_add_f32 v[36:37], v[36:37], v[60:61]
    v_pk_add_f32 v[38:39], v[38:39], v[62:63]
    v_cvt_pk_bf16_f32 v40, v32, v33
    v_cvt_pk_bf16_f32 v41, v34, v35
    v_cvt_pk_bf16_f32 v42, v36, v37
    v_cvt_pk_bf16_f32 v43, v38, v39
    v_lshlrev_b32 v32, 16, v40
    v_and_b32 v33, 0xffff0000, v40
    v_lshlrev_b32 v34, 16, v41
    v_and_b32 v35, 0xffff0000, v41
    v_lshlrev_b32 v36, 16, v42
    v_and_b32 v37, 0xffff0000, v42
    v_lshlrev_b32 v38, 16, v43
    v_and_b32 v39, 0xffff0000, v43
    v_pk_mul_f32 v[32:33], v[32:33], v[48:49]
    v_pk_mul_f32 v[34:35], v[34:35], v[50:51]
    v_pk_mul_f32 v[36:37], v[36:37], v[52:53]
    v_pk_mul_f32 v[38:39], v[38:39], v[54:55]
    v_cvt_pk_bf16_f32 v40, v32, v33
    v_cvt_pk_bf16_f32 v41, v34, v35
    v_cvt_pk_bf16_f32 v42, v36, v37
    v_cvt_pk_bf16_f32 v43, v38, v39
    v_lshlrev_b32 v32, 16, v40
    v_and_b32 v33, 0xffff0000, v40
    v_lshlrev_b32 v34, 16, v41
    v_and_b32 v35, 0xffff0000, v41
    v_lshlrev_b32 v36, 16, v42
    v_and_b32 v37, 0xffff0000, v42
    v_lshlrev_b32 v38, 16, v43
    v_and_b32 v39, 0xffff0000, v43
    v_pk_add_f32 v[32:33], v[32:33], v[72:73]
    v_pk_add_f32 v[34:35], v[34:35], v[74:75]
    v_pk_add_f32 v[36:37], v[36:37], v[76:77]
    v_pk_add_f32 v[38:39], v[38:39], v[78:79]
    v_cvt_pk_bf16_f32 v40, v32, v33
    v_cvt_pk_bf16_f32 v41, v34, v35
    v_cvt_pk_bf16_f32 v42, v36, v37
    v_cvt_pk_bf16_f32 v43, v38, v39
    buffer_store_dwordx4 v[40:43], v165, s[20:23], s54 offen sc1
M_OUT:
    s_add_u32 s40, s2, s35
    s_cmp_lg_u32 s40, 0
    s_cbranch_scc1 M_OUT2
    s_mov_b32 s44, s66
    s_mov_b32 s45, s67
    s_mov_b32 s46, 256
    s_mov_b32 s47, 0x20000
    v_mov_b32 v56, 0
    v_mov_b32 v57, 0
    v_mov_b32 v58, 0
    v_mov_b32 v59, 0
    s_mov_b64 exec, 1
    buffer_store_dwordx4 v[56:59], v56, s[44:47], 0 offen sc1
M_OUT2:
M_END:
    s_endpgm
.section .rodata,"a"
.p2align 6
.amdhsa_kernel recurrent_scan__mha_block__dense_activation_relu__prompt_kernel
  .amdhsa_next_free_vgpr 168
  .amdhsa_next_free_sgpr 76
  .amdhsa_accum_offset 168
  .amdhsa_group_segment_fixed_size 0
  .amdhsa_kernarg_size 72
  .amdhsa_user_sgpr_count 2
  .amdhsa_user_sgpr_kernarg_segment_ptr 1
  .amdhsa_system_sgpr_workgroup_id_x 1
.end_amdhsa_kernel
```
